```python
import torch

def _softmax(x, axis=-1):
    return torch.softmax(x, dim=axis)
def _gelu(x):
    return torch.nn.functional.gelu(x, approximate="tanh")
def _silu(x):
    return torch.nn.functional.silu(x)
def _sigmoid(x):
    return torch.sigmoid(x)
def _layernorm(x, axis=-1, eps=1e-5):
    m = x.mean(dim=axis, keepdim=True)
    v = x.var(dim=axis, keepdim=True, unbiased=False)
    return (x - m) / torch.sqrt(v + eps)
def _scatter_add(tgt, idx, src, axis=0):
    return tgt.clone().index_add_(axis, idx, src)
def _segment_sum(src, seg, n):
    out = torch.zeros((n,) + src.shape[1:], dtype=src.dtype)
    return out.index_add_(0, seg, src)
def _pad(x, pw):
    flat = tuple(v for pair in reversed(pw) for v in pair)
    return torch.nn.functional.pad(x, flat)

kernel_name = 'recurrent_scan__gqa_block_cached__mixer_channel_mlp__decode'

def setup_inputs():

    _w = (lambda a: (lambda t: t.to(torch.bfloat16) if t.is_floating_point() else t)(torch.as_tensor(a)))
    def _A_setup():
        B, Sq, D = 1, 1, 640
        Hq, Hkv, Sk, Dh = 32, 32, 8192, 192
        assert Hq % Hkv == 0, (Hq, Hkv)
        return {
            "x": _w((lambda *s: torch.randn(*s, dtype=torch.bfloat16) * 0.05)(B, Sq, D)),
            "k_cache": _w((lambda *s: torch.randn(*s, dtype=torch.bfloat16) * 1.6)(B, Hkv, Sk, Dh)),
            "v_cache": _w((lambda *s: torch.randn(*s, dtype=torch.bfloat16) * 1.6)(B, Hkv, Sk, Dh)),
            "wq": _w((lambda *s: torch.randn(*s, dtype=torch.bfloat16) * 1.6)(D, Hq * Dh) * (D ** -0.5)),
            "wo": _w((lambda *s: torch.randn(*s, dtype=torch.bfloat16) * 1.6)(Hq * Dh, D) * ((Hq * Dh) ** -0.5)),
        }
    _A_in = _A_setup()

    def _B_setup():
        B, S, D, F = 1, 1, 640, 1536
        return {
            "x": _w((lambda *s: torch.randn(*s, dtype=torch.bfloat16) * 0.05)(B, S, D)),
            "w1": _w((lambda *s: torch.randn(*s, dtype=torch.bfloat16) * 0.8)(D, F) * (D ** -0.5)),
            "b1": _w((lambda *s: torch.randn(*s, dtype=torch.bfloat16) * 0.4)(F)),
            "w2": _w((lambda *s: torch.randn(*s, dtype=torch.bfloat16) * 0.4)(F, D) * (F ** -0.5)),
            "b2": _w((lambda *s: torch.randn(*s, dtype=torch.bfloat16) * 0.2)(D)),
        }
    _B_in = _B_setup()

    return {
        "A_x": _A_in["x"],
        "A_k_cache": _A_in["k_cache"],
        "A_v_cache": _A_in["v_cache"],
        "A_wq": _A_in["wq"],
        "A_wo": _A_in["wo"],
        "B_x": _B_in["x"],
        "B_w1": _B_in["w1"],
        "B_b1": _B_in["b1"],
        "B_w2": _B_in["w2"],
        "B_b2": _B_in["b2"],
    }

def reference(A_x, A_k_cache, A_v_cache, A_wq, A_wo, B_x, B_w1, B_b1, B_w2, B_b2):
    def _A_ref(x, k_cache, v_cache, wq, wo):
        B, Sq, D = x.shape
        Hq, Dh = 32, 192
        Hkv = k_cache.shape[1]
        rep = Hq // Hkv
        q = (lambda x, *d: x.permute(*d))((x @ wq).reshape(B, Sq, Hq, Dh), 0, 2, 1, 3)
        k = (lambda x, n, axis: torch.repeat_interleave(x, n, dim=axis))(k_cache, rep, axis=1)
        v = (lambda x, n, axis: torch.repeat_interleave(x, n, dim=axis))(v_cache, rep, axis=1)
        scores = torch.einsum("bhqd,bhkd->bhqk", q, k) * (Dh ** -0.5)
        p = _softmax(scores, axis=-1)
        o = torch.einsum("bhqk,bhkd->bhqd", p, v)
        return (lambda x, *d: x.permute(*d))(o, 0, 2, 1, 3).reshape(B, Sq, Hq * Dh) @ wo

    def _B_ref(x, w1, b1, w2, b2):
        y = _layernorm(x, axis=-1)
        h = _gelu(torch.einsum("bsd,df->bsf", y, w1) + b1)
        return torch.einsum("bsf,fd->bsd", h, w2) + b2

    x = A_x
    xn = _layernorm(x, axis=-1)
    s = _A_ref(xn, A_k_cache, A_v_cache, A_wq, A_wo)
    g = _silu(_B_ref(xn, B_w1, B_b1, B_w2, B_b2))
    return x + s * g
```

```asm
; @launch grid=(256,1,1) block=(512,1,1) lds=51264
.amdgcn_target "amdgcn-amd-amdhsa--gfx950"
.text
.globl recurrent_scan__gqa_block_cached__mixer_channel_mlp__decode_kernel
.p2align 8
.type recurrent_scan__gqa_block_cached__mixer_channel_mlp__decode_kernel,@function
recurrent_scan__gqa_block_cached__mixer_channel_mlp__decode_kernel:
    s_cmp_ge_u32 s2, 256
    s_cbranch_scc1 L_end
    s_load_dwordx16 s[4:19], s[0:1], 0
    s_load_dwordx8 s[20:27], s[0:1], 64
    s_load_dwordx2 s[28:29], s[0:1], 96
    s_memrealtime s[86:87]
    v_and_b32 v1, 63, v0
    v_lshrrev_b32 v5, 6, v0
    s_nop 0
    v_readfirstlane_b32 s70, v5
    s_and_b32 s68, s2, 7
    s_lshl_b32 s68, s68, 2
    s_lshr_b32 s69, s2, 3
    s_and_b32 s69, s69, 3
    s_add_u32 s68, s68, s69
    s_lshr_b32 s69, s2, 5
    s_and_b32 s30, s2, 7
    s_lshl_b32 s30, s30, 5
    s_lshr_b32 s31, s2, 3
    s_add_u32 s30, s30, s31
    v_and_b32 v6, 7, v1
    v_mul_u32_u24 v2, 384, v6
    v_lshrrev_b32 v6, 3, v1
    v_lshlrev_b32 v6, 4, v6
    v_add_u32 v2, v2, v6
    v_lshrrev_b32 v7, 5, v1
    v_and_b32 v8, 31, v1
    v_mul_u32_u24 v3, 384, v7
    v_mul_u32_u24 v6, 12, v8
    v_add_u32 v3, v3, v6
    s_waitcnt lgkmcnt(0)
    s_mov_b32 s56, s4
    s_and_b32 s57, s5, 0xffff
    s_mov_b32 s58, 1280
    s_mov_b32 s59, 0x00020000
    s_mov_b32 s32, s6
    s_and_b32 s33, s7, 0xffff
    s_mov_b32 s34, 100663296
    s_mov_b32 s35, 0x00020000
    s_mov_b32 s36, s8
    s_and_b32 s37, s9, 0xffff
    s_mov_b32 s38, 100663296
    s_mov_b32 s39, 0x00020000
    s_mov_b32 s40, s10
    s_and_b32 s41, s11, 0xffff
    s_mov_b32 s42, 7864320
    s_mov_b32 s43, 0x00020000
    s_mov_b32 s44, s12
    s_and_b32 s45, s13, 0xffff
    s_mov_b32 s46, 7864320
    s_mov_b32 s47, 0x00020000
    s_mov_b32 s48, s16
    s_and_b32 s49, s17, 0xffff
    s_mov_b32 s50, 1966080
    s_mov_b32 s51, 0x00020000
    s_mov_b32 s60, s18
    s_and_b32 s61, s19, 0xffff
    s_mov_b32 s62, 3072
    s_mov_b32 s63, 0x00020000
    s_mov_b32 s52, s20
    s_and_b32 s53, s21, 0xffff
    s_mov_b32 s54, 1966080
    s_mov_b32 s55, 0x00020000
    s_mov_b32 s64, s22
    s_and_b32 s65, s23, 0xffff
    s_mov_b32 s66, 1280
    s_mov_b32 s67, 0x00020000
    s_mov_b32 s4, 0xff
    s_mov_b32 s5, 0
    s_mov_b32 s6, 0xff00
    s_mov_b32 s7, 0
    s_mov_b32 s8, 0xff0000
    s_mov_b32 s9, 0
    s_mov_b32 s10, 0xff000000
    s_mov_b32 s11, 0
    s_mov_b32 s12, 0
    s_mov_b32 s13, 0xff
    s_mov_b32 s14, 0
    s_mov_b32 s15, 0xff00
    s_mov_b32 s16, 0
    s_mov_b32 s17, 0xff0000
    s_mov_b32 s18, 0
    s_mov_b32 s19, 0xff000000
    s_mov_b32 s20, 0xff00ff00
    s_mov_b32 s21, 0xff00ff00
    s_mul_i32 s73, s68, 3145728
    s_mul_i32 s74, s69, 393216
    s_add_u32 s73, s73, s74
    s_mul_i32 s74, s70, 49152
    s_add_u32 s73, s73, s74
    s_or_b32 s86, s86, 1
    v_lshrrev_b32 v6, 5, v1
    s_lshl_b32 s72, s70, 1
    v_add_u32 v6, s72, v6
    v_mul_u32_u24 v6, 768, v6
    v_mul_u32_u24 v9, 24, v8
    v_add_u32 v13, v6, v9
    s_cmp_eq_u32 s70, 0
    s_cbranch_scc1 L_wave_q
    s_cmp_eq_u32 s70, 1
    s_cbranch_scc1 L_wave_h
    s_barrier
    s_add_u32 s72, s73, 0
    buffer_load_dwordx4 v[64:67], v2, s[32:35], s72 offen offset:0 nt
    s_add_u32 s72, s73, 0
    buffer_load_dwordx4 v[68:71], v2, s[32:35], s72 offen offset:128 nt
    s_add_u32 s72, s73, 0
    buffer_load_dwordx4 v[72:75], v2, s[32:35], s72 offen offset:256 nt
    s_add_u32 s72, s73, 3072
    buffer_load_dwordx4 v[76:79], v2, s[32:35], s72 offen offset:0 nt
    s_add_u32 s72, s73, 3072
    buffer_load_dwordx4 v[80:83], v2, s[32:35], s72 offen offset:128 nt
    s_add_u32 s72, s73, 3072
    buffer_load_dwordx4 v[84:87], v2, s[32:35], s72 offen offset:256 nt
    s_add_u32 s72, s73, 6144
    buffer_load_dwordx4 v[88:91], v2, s[32:35], s72 offen offset:0 nt
    s_add_u32 s72, s73, 6144
    buffer_load_dwordx4 v[92:95], v2, s[32:35], s72 offen offset:128 nt
    s_add_u32 s72, s73, 6144
    buffer_load_dwordx4 v[96:99], v2, s[32:35], s72 offen offset:256 nt
    s_add_u32 s72, s73, 9216
    buffer_load_dwordx4 v[100:103], v2, s[32:35], s72 offen offset:0 nt
    s_add_u32 s72, s73, 9216
    buffer_load_dwordx4 v[104:107], v2, s[32:35], s72 offen offset:128 nt
    s_add_u32 s72, s73, 9216
    buffer_load_dwordx4 v[108:111], v2, s[32:35], s72 offen offset:256 nt
    s_add_u32 s72, s73, 12288
    buffer_load_dwordx4 v[112:115], v2, s[32:35], s72 offen offset:0 nt
    s_add_u32 s72, s73, 12288
    buffer_load_dwordx4 v[116:119], v2, s[32:35], s72 offen offset:128 nt
    s_add_u32 s72, s73, 12288
    buffer_load_dwordx4 v[120:123], v2, s[32:35], s72 offen offset:256 nt
    s_add_u32 s72, s73, 15360
    buffer_load_dwordx4 v[124:127], v2, s[32:35], s72 offen offset:0 nt
    s_add_u32 s72, s73, 15360
    buffer_load_dwordx4 v[128:131], v2, s[32:35], s72 offen offset:128 nt
    s_add_u32 s72, s73, 15360
    buffer_load_dwordx4 v[132:135], v2, s[32:35], s72 offen offset:256 nt
    s_add_u32 s72, s73, 18432
    buffer_load_dwordx4 v[136:139], v2, s[32:35], s72 offen offset:0 nt
    s_add_u32 s72, s73, 18432
    buffer_load_dwordx4 v[140:143], v2, s[32:35], s72 offen offset:128 nt
    s_add_u32 s72, s73, 18432
    buffer_load_dwordx4 v[144:147], v2, s[32:35], s72 offen offset:256 nt
    s_add_u32 s72, s73, 21504
    buffer_load_dwordx4 v[148:151], v2, s[32:35], s72 offen offset:0 nt
    s_add_u32 s72, s73, 21504
    buffer_load_dwordx4 v[152:155], v2, s[32:35], s72 offen offset:128 nt
    s_add_u32 s72, s73, 21504
    buffer_load_dwordx4 v[156:159], v2, s[32:35], s72 offen offset:256 nt
    s_add_u32 s72, s73, 0
    buffer_load_dwordx3 v[160:162], v3, s[36:39], s72 offen nt
    s_add_u32 s72, s73, 768
    buffer_load_dwordx3 v[164:166], v3, s[36:39], s72 offen nt
    s_add_u32 s72, s73, 1536
    buffer_load_dwordx3 v[168:170], v3, s[36:39], s72 offen nt
    s_add_u32 s72, s73, 2304
    buffer_load_dwordx3 v[172:174], v3, s[36:39], s72 offen nt
    s_add_u32 s72, s73, 3072
    buffer_load_dwordx3 v[176:178], v3, s[36:39], s72 offen nt
    s_add_u32 s72, s73, 3840
    buffer_load_dwordx3 v[180:182], v3, s[36:39], s72 offen nt
    s_add_u32 s72, s73, 4608
    buffer_load_dwordx3 v[184:186], v3, s[36:39], s72 offen nt
    s_add_u32 s72, s73, 5376
    buffer_load_dwordx3 v[188:190], v3, s[36:39], s72 offen nt
    s_add_u32 s72, s73, 6144
    buffer_load_dwordx3 v[192:194], v3, s[36:39], s72 offen nt
    s_add_u32 s72, s73, 6912
    buffer_load_dwordx3 v[196:198], v3, s[36:39], s72 offen nt
    s_add_u32 s72, s73, 7680
    buffer_load_dwordx3 v[200:202], v3, s[36:39], s72 offen nt
    s_add_u32 s72, s73, 8448
    buffer_load_dwordx3 v[204:206], v3, s[36:39], s72 offen nt
    s_add_u32 s72, s73, 9216
    buffer_load_dwordx3 v[208:210], v3, s[36:39], s72 offen nt
    s_add_u32 s72, s73, 9984
    buffer_load_dwordx3 v[212:214], v3, s[36:39], s72 offen nt
    s_add_u32 s72, s73, 10752
    buffer_load_dwordx3 v[216:218], v3, s[36:39], s72 offen nt
    s_add_u32 s72, s73, 11520
    buffer_load_dwordx3 v[220:222], v3, s[36:39], s72 offen nt
    s_add_u32 s72, s73, 12288
    buffer_load_dwordx3 v[224:226], v3, s[36:39], s72 offen nt
    s_add_u32 s72, s73, 13056
    buffer_load_dwordx3 v[228:230], v3, s[36:39], s72 offen nt
    s_add_u32 s72, s73, 13824
    buffer_load_dwordx3 v[232:234], v3, s[36:39], s72 offen nt
    s_add_u32 s72, s73, 14592
    buffer_load_dwordx3 v[236:238], v3, s[36:39], s72 offen nt
    s_add_u32 s72, s73, 15360
    buffer_load_dwordx3 v[240:242], v3, s[36:39], s72 offen nt
    s_add_u32 s72, s73, 16128
    buffer_load_dwordx3 v[244:246], v3, s[36:39], s72 offen nt
    s_add_u32 s72, s73, 16896
    buffer_load_dwordx3 v[248:250], v3, s[36:39], s72 offen nt
    s_add_u32 s72, s73, 17664
    buffer_load_dwordx3 v[252:254], v3, s[36:39], s72 offen nt
    s_barrier
    s_branch L_join
L_wave_q:
    s_setprio 3
    v_lshlrev_b32 v5, 2, v1
    buffer_load_dword v47, v5, s[56:59], 0 offen offset:0
    buffer_load_dword v48, v5, s[56:59], 0 offen offset:256
    buffer_load_dword v49, v5, s[56:59], 0 offen offset:512
    buffer_load_dword v50, v5, s[56:59], 0 offen offset:768
    buffer_load_dword v51, v5, s[56:59], 0 offen offset:1024
    s_mul_i32 s71, s69, 80
    v_add_u32 v4, s71, v7
    v_mov_b32 v9, 12288
    v_mul_lo_u32 v4, v4, v9
    v_mul_u32_u24 v6, 12, v8
    v_add_u32 v4, v4, v6
    s_mul_i32 s72, s68, 384
    v_add_u32 v4, s72, v4
    s_mov_b32 s72, 0
    buffer_load_dwordx3 v[64:66], v4, s[40:43], s72 offen
    s_add_u32 s72, s72, 24576
    buffer_load_dwordx3 v[68:70], v4, s[40:43], s72 offen
    s_add_u32 s72, s72, 24576
    buffer_load_dwordx3 v[72:74], v4, s[40:43], s72 offen
    s_add_u32 s72, s72, 24576
    buffer_load_dwordx3 v[76:78], v4, s[40:43], s72 offen
    s_add_u32 s72, s72, 24576
    buffer_load_dwordx3 v[80:82], v4, s[40:43], s72 offen
    s_add_u32 s72, s72, 24576
    buffer_load_dwordx3 v[84:86], v4, s[40:43], s72 offen
    s_add_u32 s72, s72, 24576
    buffer_load_dwordx3 v[88:90], v4, s[40:43], s72 offen
    s_add_u32 s72, s72, 24576
    buffer_load_dwordx3 v[92:94], v4, s[40:43], s72 offen
    s_add_u32 s72, s72, 24576
    buffer_load_dwordx3 v[96:98], v4, s[40:43], s72 offen
    s_add_u32 s72, s72, 24576
    buffer_load_dwordx3 v[100:102], v4, s[40:43], s72 offen
    s_add_u32 s72, s72, 24576
    buffer_load_dwordx3 v[104:106], v4, s[40:43], s72 offen
    s_add_u32 s72, s72, 24576
    buffer_load_dwordx3 v[108:110], v4, s[40:43], s72 offen
    s_add_u32 s72, s72, 24576
    buffer_load_dwordx3 v[112:114], v4, s[40:43], s72 offen
    s_add_u32 s72, s72, 24576
    buffer_load_dwordx3 v[116:118], v4, s[40:43], s72 offen
    s_add_u32 s72, s72, 24576
    buffer_load_dwordx3 v[120:122], v4, s[40:43], s72 offen
    s_add_u32 s72, s72, 24576
    buffer_load_dwordx3 v[124:126], v4, s[40:43], s72 offen
    s_add_u32 s72, s72, 24576
    buffer_load_dwordx3 v[128:130], v4, s[40:43], s72 offen
    s_add_u32 s72, s72, 24576
    buffer_load_dwordx3 v[132:134], v4, s[40:43], s72 offen
    s_add_u32 s72, s72, 24576
    buffer_load_dwordx3 v[136:138], v4, s[40:43], s72 offen
    s_add_u32 s72, s72, 24576
    buffer_load_dwordx3 v[140:142], v4, s[40:43], s72 offen
    s_add_u32 s72, s72, 24576
    buffer_load_dwordx3 v[144:146], v4, s[40:43], s72 offen
    s_add_u32 s72, s72, 24576
    buffer_load_dwordx3 v[148:150], v4, s[40:43], s72 offen
    s_add_u32 s72, s72, 24576
    buffer_load_dwordx3 v[152:154], v4, s[40:43], s72 offen
    s_add_u32 s72, s72, 24576
    buffer_load_dwordx3 v[156:158], v4, s[40:43], s72 offen
    s_add_u32 s72, s72, 24576
    buffer_load_dwordx3 v[160:162], v4, s[40:43], s72 offen
    s_add_u32 s72, s72, 24576
    buffer_load_dwordx3 v[164:166], v4, s[40:43], s72 offen
    s_add_u32 s72, s72, 24576
    buffer_load_dwordx3 v[168:170], v4, s[40:43], s72 offen
    s_add_u32 s72, s72, 24576
    buffer_load_dwordx3 v[172:174], v4, s[40:43], s72 offen
    s_add_u32 s72, s72, 24576
    buffer_load_dwordx3 v[176:178], v4, s[40:43], s72 offen
    s_add_u32 s72, s72, 24576
    buffer_load_dwordx3 v[180:182], v4, s[40:43], s72 offen
    s_add_u32 s72, s72, 24576
    buffer_load_dwordx3 v[184:186], v4, s[40:43], s72 offen
    s_add_u32 s72, s72, 24576
    buffer_load_dwordx3 v[188:190], v4, s[40:43], s72 offen
    s_add_u32 s72, s72, 24576
    buffer_load_dwordx3 v[192:194], v4, s[40:43], s72 offen
    s_add_u32 s72, s72, 24576
    buffer_load_dwordx3 v[196:198], v4, s[40:43], s72 offen
    s_add_u32 s72, s72, 24576
    buffer_load_dwordx3 v[200:202], v4, s[40:43], s72 offen
    s_add_u32 s72, s72, 24576
    buffer_load_dwordx3 v[204:206], v4, s[40:43], s72 offen
    s_add_u32 s72, s72, 24576
    buffer_load_dwordx3 v[208:210], v4, s[40:43], s72 offen
    s_add_u32 s72, s72, 24576
    buffer_load_dwordx3 v[212:214], v4, s[40:43], s72 offen
    s_add_u32 s72, s72, 24576
    buffer_load_dwordx3 v[216:218], v4, s[40:43], s72 offen
    s_add_u32 s72, s72, 24576
    buffer_load_dwordx3 v[220:222], v4, s[40:43], s72 offen
    s_lshl_b32 s72, s68, 3
    v_mov_b32 v9, s72
    v_mov_b32 v10, s86
    v_mov_b32 v11, 0
    s_mov_b32 exec_lo, 1
    s_mov_b32 exec_hi, 0
    global_atomic_cmpswap v12, v9, v[10:11], s[26:27] sc0 sc1
    s_mov_b64 exec, -1
    s_barrier
    s_waitcnt vmcnt(41)
    v_lshlrev_b32 v52, 16, v47
    v_and_b32 v53, 0xffff0000, v47
    v_lshlrev_b32 v54, 16, v48
    v_and_b32 v55, 0xffff0000, v48
    v_lshlrev_b32 v56, 16, v49
    v_and_b32 v57, 0xffff0000, v49
    v_lshlrev_b32 v58, 16, v50
    v_and_b32 v59, 0xffff0000, v50
    v_lshlrev_b32 v60, 16, v51
    v_and_b32 v61, 0xffff0000, v51
    v_add_f32 v43, v52, v53
    v_add_f32 v43, v43, v54
    v_add_f32 v43, v43, v55
    v_add_f32 v43, v43, v56
    v_add_f32 v43, v43, v57
    v_add_f32 v43, v43, v58
    v_add_f32 v43, v43, v59
    v_add_f32 v43, v43, v60
    v_add_f32 v43, v43, v61
    s_nop 1
    v_add_f32_dpp v43, v43, v43 row_shr:1 row_mask:0xf bank_mask:0xf
    s_nop 1
    v_add_f32_dpp v43, v43, v43 row_shr:2 row_mask:0xf bank_mask:0xf
    s_nop 1
    v_add_f32_dpp v43, v43, v43 row_shr:4 row_mask:0xf bank_mask:0xf
    s_nop 1
    v_add_f32_dpp v43, v43, v43 row_shr:8 row_mask:0xf bank_mask:0xf
    s_nop 1
    v_add_f32_dpp v43, v43, v43 row_bcast:15 row_mask:0xa bank_mask:0xf
    s_nop 1
    v_add_f32_dpp v43, v43, v43 row_bcast:31 row_mask:0xc bank_mask:0xf
    s_nop 0
    v_readlane_b32 s74, v43, 63
    s_nop 1
    v_mov_b32 v62, 0x3acccccd
    v_mul_f32 v62, s74, v62
    v_sub_f32 v63, v52, v62
    v_mul_f32 v43, v63, v63
    v_sub_f32 v63, v53, v62
    v_fma_f32 v43, v63, v63, v43
    v_sub_f32 v63, v54, v62
    v_fma_f32 v43, v63, v63, v43
    v_sub_f32 v63, v55, v62
    v_fma_f32 v43, v63, v63, v43
    v_sub_f32 v63, v56, v62
    v_fma_f32 v43, v63, v63, v43
    v_sub_f32 v63, v57, v62
    v_fma_f32 v43, v63, v63, v43
    v_sub_f32 v63, v58, v62
    v_fma_f32 v43, v63, v63, v43
    v_sub_f32 v63, v59, v62
    v_fma_f32 v43, v63, v63, v43
    v_sub_f32 v63, v60, v62
    v_fma_f32 v43, v63, v63, v43
    v_sub_f32 v63, v61, v62
    v_fma_f32 v43, v63, v63, v43
    s_nop 1
    v_add_f32_dpp v43, v43, v43 row_shr:1 row_mask:0xf bank_mask:0xf
    s_nop 1
    v_add_f32_dpp v43, v43, v43 row_shr:2 row_mask:0xf bank_mask:0xf
    s_nop 1
    v_add_f32_dpp v43, v43, v43 row_shr:4 row_mask:0xf bank_mask:0xf
    s_nop 1
    v_add_f32_dpp v43, v43, v43 row_shr:8 row_mask:0xf bank_mask:0xf
    s_nop 1
    v_add_f32_dpp v43, v43, v43 row_bcast:15 row_mask:0xa bank_mask:0xf
    s_nop 1
    v_add_f32_dpp v43, v43, v43 row_bcast:31 row_mask:0xc bank_mask:0xf
    s_nop 0
    v_readlane_b32 s74, v43, 63
    s_nop 1
    v_mov_b32 v63, 0x3acccccd
    v_mul_f32 v63, s74, v63
    v_cvt_pk_bf16_f32 v62, v62, v62
    v_and_b32 v62, 0xffff0000, v62
    v_cvt_pk_bf16_f32 v63, v63, v63
    v_and_b32 v63, 0xffff0000, v63
    v_add_f32 v63, 0x3727c5ac, v63
    v_cvt_pk_bf16_f32 v63, v63, v63
    v_and_b32 v63, 0xffff0000, v63
    v_sqrt_f32 v63, v63
    s_nop 0
    v_cvt_pk_bf16_f32 v63, v63, v63
    v_and_b32 v63, 0xffff0000, v63
    v_rcp_f32 v63, v63
    s_nop 0
    v_sub_f32 v52, v52, v62
    v_cvt_pk_bf16_f32 v52, v52, v52
    v_and_b32 v52, 0xffff0000, v52
    v_mul_f32 v52, v52, v63
    v_cvt_pk_bf16_f32 v52, v52, v52
    v_and_b32 v52, 0xffff0000, v52
    v_sub_f32 v53, v53, v62
    v_cvt_pk_bf16_f32 v53, v53, v53
    v_and_b32 v53, 0xffff0000, v53
    v_mul_f32 v53, v53, v63
    v_cvt_pk_bf16_f32 v53, v53, v53
    v_and_b32 v53, 0xffff0000, v53
    v_sub_f32 v54, v54, v62
    v_cvt_pk_bf16_f32 v54, v54, v54
    v_and_b32 v54, 0xffff0000, v54
    v_mul_f32 v54, v54, v63
    v_cvt_pk_bf16_f32 v54, v54, v54
    v_and_b32 v54, 0xffff0000, v54
    v_sub_f32 v55, v55, v62
    v_cvt_pk_bf16_f32 v55, v55, v55
    v_and_b32 v55, 0xffff0000, v55
    v_mul_f32 v55, v55, v63
    v_cvt_pk_bf16_f32 v55, v55, v55
    v_and_b32 v55, 0xffff0000, v55
    v_sub_f32 v56, v56, v62
    v_cvt_pk_bf16_f32 v56, v56, v56
    v_and_b32 v56, 0xffff0000, v56
    v_mul_f32 v56, v56, v63
    v_cvt_pk_bf16_f32 v56, v56, v56
    v_and_b32 v56, 0xffff0000, v56
    v_sub_f32 v57, v57, v62
    v_cvt_pk_bf16_f32 v57, v57, v57
    v_and_b32 v57, 0xffff0000, v57
    v_mul_f32 v57, v57, v63
    v_cvt_pk_bf16_f32 v57, v57, v57
    v_and_b32 v57, 0xffff0000, v57
    v_sub_f32 v58, v58, v62
    v_cvt_pk_bf16_f32 v58, v58, v58
    v_and_b32 v58, 0xffff0000, v58
    v_mul_f32 v58, v58, v63
    v_cvt_pk_bf16_f32 v58, v58, v58
    v_and_b32 v58, 0xffff0000, v58
    v_sub_f32 v59, v59, v62
    v_cvt_pk_bf16_f32 v59, v59, v59
    v_and_b32 v59, 0xffff0000, v59
    v_mul_f32 v59, v59, v63
    v_cvt_pk_bf16_f32 v59, v59, v59
    v_and_b32 v59, 0xffff0000, v59
    v_sub_f32 v60, v60, v62
    v_cvt_pk_bf16_f32 v60, v60, v60
    v_and_b32 v60, 0xffff0000, v60
    v_mul_f32 v60, v60, v63
    v_cvt_pk_bf16_f32 v60, v60, v60
    v_and_b32 v60, 0xffff0000, v60
    v_sub_f32 v61, v61, v62
    v_cvt_pk_bf16_f32 v61, v61, v61
    v_and_b32 v61, 0xffff0000, v61
    v_mul_f32 v61, v61, v63
    v_cvt_pk_bf16_f32 v61, v61, v61
    v_and_b32 v61, 0xffff0000, v61
    v_lshlrev_b32 v5, 3, v1
    ds_write_b64 v5, v[52:53] offset:0
    ds_write_b64 v5, v[54:55] offset:512
    ds_write_b64 v5, v[56:57] offset:1024
    ds_write_b64 v5, v[58:59] offset:1536
    ds_write_b64 v5, v[60:61] offset:2048
    s_waitcnt lgkmcnt(0)
    v_mov_b32 v56, 0
    v_mov_b32 v57, 0
    v_mov_b32 v58, 0
    v_mov_b32 v59, 0
    v_mov_b32 v60, 0
    v_mov_b32 v61, 0
    v_lshrrev_b32 v5, 5, v1
    v_add_u32 v5, s71, v5
    v_lshlrev_b32 v5, 2, v5
    ds_read_b32 v67, v5 offset:0
    ds_read_b32 v71, v5 offset:8
    ds_read_b32 v75, v5 offset:16
    ds_read_b32 v79, v5 offset:24
    ds_read_b32 v83, v5 offset:32
    ds_read_b32 v87, v5 offset:40
    ds_read_b32 v91, v5 offset:48
    ds_read_b32 v95, v5 offset:56
    ds_read_b32 v99, v5 offset:64
    ds_read_b32 v103, v5 offset:72
    ds_read_b32 v107, v5 offset:80
    ds_read_b32 v111, v5 offset:88
    ds_read_b32 v115, v5 offset:96
    ds_read_b32 v119, v5 offset:104
    ds_read_b32 v123, v5 offset:112
    ds_read_b32 v127, v5 offset:120
    ds_read_b32 v131, v5 offset:128
    ds_read_b32 v135, v5 offset:136
    ds_read_b32 v139, v5 offset:144
    ds_read_b32 v143, v5 offset:152
    ds_read_b32 v147, v5 offset:160
    ds_read_b32 v151, v5 offset:168
    ds_read_b32 v155, v5 offset:176
    ds_read_b32 v159, v5 offset:184
    ds_read_b32 v163, v5 offset:192
    ds_read_b32 v167, v5 offset:200
    ds_read_b32 v171, v5 offset:208
    ds_read_b32 v175, v5 offset:216
    ds_read_b32 v179, v5 offset:224
    ds_read_b32 v183, v5 offset:232
    ds_read_b32 v187, v5 offset:240
    ds_read_b32 v191, v5 offset:248
    ds_read_b32 v195, v5 offset:256
    ds_read_b32 v199, v5 offset:264
    ds_read_b32 v203, v5 offset:272
    ds_read_b32 v207, v5 offset:280
    ds_read_b32 v211, v5 offset:288
    ds_read_b32 v215, v5 offset:296
    ds_read_b32 v219, v5 offset:304
    ds_read_b32 v223, v5 offset:312
    s_waitcnt lgkmcnt(0)
    s_waitcnt vmcnt(31)
    v_lshrrev_b32 v14, 16, v67
    v_dot2_f32_bf16 v56, v64, v14, v56
    v_dot2_f32_bf16 v57, v64, v67, v57
    v_dot2_f32_bf16 v58, v65, v14, v58
    v_dot2_f32_bf16 v59, v65, v67, v59
    v_dot2_f32_bf16 v60, v66, v14, v60
    v_dot2_f32_bf16 v61, v66, v67, v61
    v_lshrrev_b32 v14, 16, v71
    v_dot2_f32_bf16 v56, v68, v14, v56
    v_dot2_f32_bf16 v57, v68, v71, v57
    v_dot2_f32_bf16 v58, v69, v14, v58
    v_dot2_f32_bf16 v59, v69, v71, v59
    v_dot2_f32_bf16 v60, v70, v14, v60
    v_dot2_f32_bf16 v61, v70, v71, v61
    v_lshrrev_b32 v14, 16, v75
    v_dot2_f32_bf16 v56, v72, v14, v56
    v_dot2_f32_bf16 v57, v72, v75, v57
    v_dot2_f32_bf16 v58, v73, v14, v58
    v_dot2_f32_bf16 v59, v73, v75, v59
    v_dot2_f32_bf16 v60, v74, v14, v60
    v_dot2_f32_bf16 v61, v74, v75, v61
    v_lshrrev_b32 v14, 16, v79
    v_dot2_f32_bf16 v56, v76, v14, v56
    v_dot2_f32_bf16 v57, v76, v79, v57
    v_dot2_f32_bf16 v58, v77, v14, v58
    v_dot2_f32_bf16 v59, v77, v79, v59
    v_dot2_f32_bf16 v60, v78, v14, v60
    v_dot2_f32_bf16 v61, v78, v79, v61
    v_lshrrev_b32 v14, 16, v83
    v_dot2_f32_bf16 v56, v80, v14, v56
    v_dot2_f32_bf16 v57, v80, v83, v57
    v_dot2_f32_bf16 v58, v81, v14, v58
    v_dot2_f32_bf16 v59, v81, v83, v59
    v_dot2_f32_bf16 v60, v82, v14, v60
    v_dot2_f32_bf16 v61, v82, v83, v61
    v_lshrrev_b32 v14, 16, v87
    v_dot2_f32_bf16 v56, v84, v14, v56
    v_dot2_f32_bf16 v57, v84, v87, v57
    v_dot2_f32_bf16 v58, v85, v14, v58
    v_dot2_f32_bf16 v59, v85, v87, v59
    v_dot2_f32_bf16 v60, v86, v14, v60
    v_dot2_f32_bf16 v61, v86, v87, v61
    v_lshrrev_b32 v14, 16, v91
    v_dot2_f32_bf16 v56, v88, v14, v56
    v_dot2_f32_bf16 v57, v88, v91, v57
    v_dot2_f32_bf16 v58, v89, v14, v58
    v_dot2_f32_bf16 v59, v89, v91, v59
    v_dot2_f32_bf16 v60, v90, v14, v60
    v_dot2_f32_bf16 v61, v90, v91, v61
    v_lshrrev_b32 v14, 16, v95
    v_dot2_f32_bf16 v56, v92, v14, v56
    v_dot2_f32_bf16 v57, v92, v95, v57
    v_dot2_f32_bf16 v58, v93, v14, v58
    v_dot2_f32_bf16 v59, v93, v95, v59
    v_dot2_f32_bf16 v60, v94, v14, v60
    v_dot2_f32_bf16 v61, v94, v95, v61
    v_lshrrev_b32 v14, 16, v99
    v_dot2_f32_bf16 v56, v96, v14, v56
    v_dot2_f32_bf16 v57, v96, v99, v57
    v_dot2_f32_bf16 v58, v97, v14, v58
    v_dot2_f32_bf16 v59, v97, v99, v59
    v_dot2_f32_bf16 v60, v98, v14, v60
    v_dot2_f32_bf16 v61, v98, v99, v61
    v_lshrrev_b32 v14, 16, v103
    v_dot2_f32_bf16 v56, v100, v14, v56
    v_dot2_f32_bf16 v57, v100, v103, v57
    v_dot2_f32_bf16 v58, v101, v14, v58
    v_dot2_f32_bf16 v59, v101, v103, v59
    v_dot2_f32_bf16 v60, v102, v14, v60
    v_dot2_f32_bf16 v61, v102, v103, v61
    s_waitcnt vmcnt(21)
    v_lshrrev_b32 v14, 16, v107
    v_dot2_f32_bf16 v56, v104, v14, v56
    v_dot2_f32_bf16 v57, v104, v107, v57
    v_dot2_f32_bf16 v58, v105, v14, v58
    v_dot2_f32_bf16 v59, v105, v107, v59
    v_dot2_f32_bf16 v60, v106, v14, v60
    v_dot2_f32_bf16 v61, v106, v107, v61
    v_lshrrev_b32 v14, 16, v111
    v_dot2_f32_bf16 v56, v108, v14, v56
    v_dot2_f32_bf16 v57, v108, v111, v57
    v_dot2_f32_bf16 v58, v109, v14, v58
    v_dot2_f32_bf16 v59, v109, v111, v59
    v_dot2_f32_bf16 v60, v110, v14, v60
    v_dot2_f32_bf16 v61, v110, v111, v61
    v_lshrrev_b32 v14, 16, v115
    v_dot2_f32_bf16 v56, v112, v14, v56
    v_dot2_f32_bf16 v57, v112, v115, v57
    v_dot2_f32_bf16 v58, v113, v14, v58
    v_dot2_f32_bf16 v59, v113, v115, v59
    v_dot2_f32_bf16 v60, v114, v14, v60
    v_dot2_f32_bf16 v61, v114, v115, v61
    v_lshrrev_b32 v14, 16, v119
    v_dot2_f32_bf16 v56, v116, v14, v56
    v_dot2_f32_bf16 v57, v116, v119, v57
    v_dot2_f32_bf16 v58, v117, v14, v58
    v_dot2_f32_bf16 v59, v117, v119, v59
    v_dot2_f32_bf16 v60, v118, v14, v60
    v_dot2_f32_bf16 v61, v118, v119, v61
    v_lshrrev_b32 v14, 16, v123
    v_dot2_f32_bf16 v56, v120, v14, v56
    v_dot2_f32_bf16 v57, v120, v123, v57
    v_dot2_f32_bf16 v58, v121, v14, v58
    v_dot2_f32_bf16 v59, v121, v123, v59
    v_dot2_f32_bf16 v60, v122, v14, v60
    v_dot2_f32_bf16 v61, v122, v123, v61
    v_lshrrev_b32 v14, 16, v127
    v_dot2_f32_bf16 v56, v124, v14, v56
    v_dot2_f32_bf16 v57, v124, v127, v57
    v_dot2_f32_bf16 v58, v125, v14, v58
    v_dot2_f32_bf16 v59, v125, v127, v59
    v_dot2_f32_bf16 v60, v126, v14, v60
    v_dot2_f32_bf16 v61, v126, v127, v61
    v_lshrrev_b32 v14, 16, v131
    v_dot2_f32_bf16 v56, v128, v14, v56
    v_dot2_f32_bf16 v57, v128, v131, v57
    v_dot2_f32_bf16 v58, v129, v14, v58
    v_dot2_f32_bf16 v59, v129, v131, v59
    v_dot2_f32_bf16 v60, v130, v14, v60
    v_dot2_f32_bf16 v61, v130, v131, v61
    v_lshrrev_b32 v14, 16, v135
    v_dot2_f32_bf16 v56, v132, v14, v56
    v_dot2_f32_bf16 v57, v132, v135, v57
    v_dot2_f32_bf16 v58, v133, v14, v58
    v_dot2_f32_bf16 v59, v133, v135, v59
    v_dot2_f32_bf16 v60, v134, v14, v60
    v_dot2_f32_bf16 v61, v134, v135, v61
    v_lshrrev_b32 v14, 16, v139
    v_dot2_f32_bf16 v56, v136, v14, v56
    v_dot2_f32_bf16 v57, v136, v139, v57
    v_dot2_f32_bf16 v58, v137, v14, v58
    v_dot2_f32_bf16 v59, v137, v139, v59
    v_dot2_f32_bf16 v60, v138, v14, v60
    v_dot2_f32_bf16 v61, v138, v139, v61
    v_lshrrev_b32 v14, 16, v143
    v_dot2_f32_bf16 v56, v140, v14, v56
    v_dot2_f32_bf16 v57, v140, v143, v57
    v_dot2_f32_bf16 v58, v141, v14, v58
    v_dot2_f32_bf16 v59, v141, v143, v59
    v_dot2_f32_bf16 v60, v142, v14, v60
    v_dot2_f32_bf16 v61, v142, v143, v61
    s_waitcnt vmcnt(11)
    v_lshrrev_b32 v14, 16, v147
    v_dot2_f32_bf16 v56, v144, v14, v56
    v_dot2_f32_bf16 v57, v144, v147, v57
    v_dot2_f32_bf16 v58, v145, v14, v58
    v_dot2_f32_bf16 v59, v145, v147, v59
    v_dot2_f32_bf16 v60, v146, v14, v60
    v_dot2_f32_bf16 v61, v146, v147, v61
    v_lshrrev_b32 v14, 16, v151
    v_dot2_f32_bf16 v56, v148, v14, v56
    v_dot2_f32_bf16 v57, v148, v151, v57
    v_dot2_f32_bf16 v58, v149, v14, v58
    v_dot2_f32_bf16 v59, v149, v151, v59
    v_dot2_f32_bf16 v60, v150, v14, v60
    v_dot2_f32_bf16 v61, v150, v151, v61
    v_lshrrev_b32 v14, 16, v155
    v_dot2_f32_bf16 v56, v152, v14, v56
    v_dot2_f32_bf16 v57, v152, v155, v57
    v_dot2_f32_bf16 v58, v153, v14, v58
    v_dot2_f32_bf16 v59, v153, v155, v59
    v_dot2_f32_bf16 v60, v154, v14, v60
    v_dot2_f32_bf16 v61, v154, v155, v61
    v_lshrrev_b32 v14, 16, v159
    v_dot2_f32_bf16 v56, v156, v14, v56
    v_dot2_f32_bf16 v57, v156, v159, v57
    v_dot2_f32_bf16 v58, v157, v14, v58
    v_dot2_f32_bf16 v59, v157, v159, v59
    v_dot2_f32_bf16 v60, v158, v14, v60
    v_dot2_f32_bf16 v61, v158, v159, v61
    v_lshrrev_b32 v14, 16, v163
    v_dot2_f32_bf16 v56, v160, v14, v56
    v_dot2_f32_bf16 v57, v160, v163, v57
    v_dot2_f32_bf16 v58, v161, v14, v58
    v_dot2_f32_bf16 v59, v161, v163, v59
    v_dot2_f32_bf16 v60, v162, v14, v60
    v_dot2_f32_bf16 v61, v162, v163, v61
    v_lshrrev_b32 v14, 16, v167
    v_dot2_f32_bf16 v56, v164, v14, v56
    v_dot2_f32_bf16 v57, v164, v167, v57
    v_dot2_f32_bf16 v58, v165, v14, v58
    v_dot2_f32_bf16 v59, v165, v167, v59
    v_dot2_f32_bf16 v60, v166, v14, v60
    v_dot2_f32_bf16 v61, v166, v167, v61
    v_lshrrev_b32 v14, 16, v171
    v_dot2_f32_bf16 v56, v168, v14, v56
    v_dot2_f32_bf16 v57, v168, v171, v57
    v_dot2_f32_bf16 v58, v169, v14, v58
    v_dot2_f32_bf16 v59, v169, v171, v59
    v_dot2_f32_bf16 v60, v170, v14, v60
    v_dot2_f32_bf16 v61, v170, v171, v61
    v_lshrrev_b32 v14, 16, v175
    v_dot2_f32_bf16 v56, v172, v14, v56
    v_dot2_f32_bf16 v57, v172, v175, v57
    v_dot2_f32_bf16 v58, v173, v14, v58
    v_dot2_f32_bf16 v59, v173, v175, v59
    v_dot2_f32_bf16 v60, v174, v14, v60
    v_dot2_f32_bf16 v61, v174, v175, v61
    v_lshrrev_b32 v14, 16, v179
    v_dot2_f32_bf16 v56, v176, v14, v56
    v_dot2_f32_bf16 v57, v176, v179, v57
    v_dot2_f32_bf16 v58, v177, v14, v58
    v_dot2_f32_bf16 v59, v177, v179, v59
    v_dot2_f32_bf16 v60, v178, v14, v60
    v_dot2_f32_bf16 v61, v178, v179, v61
    v_lshrrev_b32 v14, 16, v183
    v_dot2_f32_bf16 v56, v180, v14, v56
    v_dot2_f32_bf16 v57, v180, v183, v57
    v_dot2_f32_bf16 v58, v181, v14, v58
    v_dot2_f32_bf16 v59, v181, v183, v59
    v_dot2_f32_bf16 v60, v182, v14, v60
    v_dot2_f32_bf16 v61, v182, v183, v61
    s_waitcnt vmcnt(1)
    v_lshrrev_b32 v14, 16, v187
    v_dot2_f32_bf16 v56, v184, v14, v56
    v_dot2_f32_bf16 v57, v184, v187, v57
    v_dot2_f32_bf16 v58, v185, v14, v58
    v_dot2_f32_bf16 v59, v185, v187, v59
    v_dot2_f32_bf16 v60, v186, v14, v60
    v_dot2_f32_bf16 v61, v186, v187, v61
    v_lshrrev_b32 v14, 16, v191
    v_dot2_f32_bf16 v56, v188, v14, v56
    v_dot2_f32_bf16 v57, v188, v191, v57
    v_dot2_f32_bf16 v58, v189, v14, v58
    v_dot2_f32_bf16 v59, v189, v191, v59
    v_dot2_f32_bf16 v60, v190, v14, v60
    v_dot2_f32_bf16 v61, v190, v191, v61
    v_lshrrev_b32 v14, 16, v195
    v_dot2_f32_bf16 v56, v192, v14, v56
    v_dot2_f32_bf16 v57, v192, v195, v57
    v_dot2_f32_bf16 v58, v193, v14, v58
    v_dot2_f32_bf16 v59, v193, v195, v59
    v_dot2_f32_bf16 v60, v194, v14, v60
    v_dot2_f32_bf16 v61, v194, v195, v61
    v_lshrrev_b32 v14, 16, v199
    v_dot2_f32_bf16 v56, v196, v14, v56
    v_dot2_f32_bf16 v57, v196, v199, v57
    v_dot2_f32_bf16 v58, v197, v14, v58
    v_dot2_f32_bf16 v59, v197, v199, v59
    v_dot2_f32_bf16 v60, v198, v14, v60
    v_dot2_f32_bf16 v61, v198, v199, v61
    v_lshrrev_b32 v14, 16, v203
    v_dot2_f32_bf16 v56, v200, v14, v56
    v_dot2_f32_bf16 v57, v200, v203, v57
    v_dot2_f32_bf16 v58, v201, v14, v58
    v_dot2_f32_bf16 v59, v201, v203, v59
    v_dot2_f32_bf16 v60, v202, v14, v60
    v_dot2_f32_bf16 v61, v202, v203, v61
    v_lshrrev_b32 v14, 16, v207
    v_dot2_f32_bf16 v56, v204, v14, v56
    v_dot2_f32_bf16 v57, v204, v207, v57
    v_dot2_f32_bf16 v58, v205, v14, v58
    v_dot2_f32_bf16 v59, v205, v207, v59
    v_dot2_f32_bf16 v60, v206, v14, v60
    v_dot2_f32_bf16 v61, v206, v207, v61
    v_lshrrev_b32 v14, 16, v211
    v_dot2_f32_bf16 v56, v208, v14, v56
    v_dot2_f32_bf16 v57, v208, v211, v57
    v_dot2_f32_bf16 v58, v209, v14, v58
    v_dot2_f32_bf16 v59, v209, v211, v59
    v_dot2_f32_bf16 v60, v210, v14, v60
    v_dot2_f32_bf16 v61, v210, v211, v61
    v_lshrrev_b32 v14, 16, v215
    v_dot2_f32_bf16 v56, v212, v14, v56
    v_dot2_f32_bf16 v57, v212, v215, v57
    v_dot2_f32_bf16 v58, v213, v14, v58
    v_dot2_f32_bf16 v59, v213, v215, v59
    v_dot2_f32_bf16 v60, v214, v14, v60
    v_dot2_f32_bf16 v61, v214, v215, v61
    v_lshrrev_b32 v14, 16, v219
    v_dot2_f32_bf16 v56, v216, v14, v56
    v_dot2_f32_bf16 v57, v216, v219, v57
    v_dot2_f32_bf16 v58, v217, v14, v58
    v_dot2_f32_bf16 v59, v217, v219, v59
    v_dot2_f32_bf16 v60, v218, v14, v60
    v_dot2_f32_bf16 v61, v218, v219, v61
    v_lshrrev_b32 v14, 16, v223
    v_dot2_f32_bf16 v56, v220, v14, v56
    v_dot2_f32_bf16 v57, v220, v223, v57
    v_dot2_f32_bf16 v58, v221, v14, v58
    v_dot2_f32_bf16 v59, v221, v223, v59
    v_dot2_f32_bf16 v60, v222, v14, v60
    v_dot2_f32_bf16 v61, v222, v223, v61
    s_nop 2
    ds_write_b64 v13, v[56:57] offset:5120
    ds_write_b64 v13, v[58:59] offset:5128
    ds_write_b64 v13, v[60:61] offset:5136
    v_mul_u32_u24 v5, 12, v1
    s_waitcnt lgkmcnt(0)
    ds_read_b32 v16, v5 offset:5120
    ds_read_b32 v20, v5 offset:5888
    ds_read_b32 v17, v5 offset:5124
    ds_read_b32 v21, v5 offset:5892
    ds_read_b32 v18, v5 offset:5128
    ds_read_b32 v22, v5 offset:5896
    s_waitcnt vmcnt(0)
    v_readfirstlane_b32 s87, v12
    s_nop 2
    s_cmp_eq_u32 s87, 0
    s_cselect_b32 s86, s86, s87
    s_waitcnt lgkmcnt(0)
    v_add_f32 v16, v16, v20
    v_add_f32 v17, v17, v21
    v_add_f32 v18, v18, v22
    v_mov_b32 v19, s86
    s_lshl_b32 s72, s68, 3
    s_add_u32 s72, s72, s69
    s_lshl_b32 s72, s72, 10
    v_lshlrev_b32 v9, 4, v1
    v_add_u32 v5, s72, v9
    global_store_dwordx4 v5, v[16:19], s[28:29] offset:0 sc1
    v_mov_b32 v5, 0
    v_mov_b32 v6, s86
    ds_write_b32 v5, v6 offset:18400
    s_lshl_b32 s72, s68, 13
    v_add_u32 v9, s72, v9
    s_mov_b32 s74, 0
L_qg:
    global_load_dwordx4 v[64:67], v9, s[28:29] offset:0 sc1
    global_load_dwordx4 v[68:71], v9, s[28:29] offset:1024 sc1
    global_load_dwordx4 v[72:75], v9, s[28:29] offset:2048 sc1
    global_load_dwordx4 v[76:79], v9, s[28:29] offset:3072 sc1
    v_add_u32 v10, 4096, v9
    global_load_dwordx4 v[80:83], v10, s[28:29] offset:0 sc1
    global_load_dwordx4 v[84:87], v10, s[28:29] offset:1024 sc1
    global_load_dwordx4 v[88:91], v10, s[28:29] offset:2048 sc1
    global_load_dwordx4 v[92:95], v10, s[28:29] offset:3072 sc1
    s_waitcnt vmcnt(0)
    v_cmp_ne_u32 vcc, s86, v67
    v_cmp_ne_u32 s[78:79], s86, v71
    s_nop 0
    s_or_b64 vcc, vcc, s[78:79]
    v_cmp_ne_u32 s[78:79], s86, v75
    s_nop 0
    s_or_b64 vcc, vcc, s[78:79]
    v_cmp_ne_u32 s[78:79], s86, v79
    s_nop 0
    s_or_b64 vcc, vcc, s[78:79]
    v_cmp_ne_u32 s[78:79], s86, v83
    s_nop 0
    s_or_b64 vcc, vcc, s[78:79]
    v_cmp_ne_u32 s[78:79], s86, v87
    s_nop 0
    s_or_b64 vcc, vcc, s[78:79]
    v_cmp_ne_u32 s[78:79], s86, v91
    s_nop 0
    s_or_b64 vcc, vcc, s[78:79]
    v_cmp_ne_u32 s[78:79], s86, v95
    s_nop 0
    s_or_b64 vcc, vcc, s[78:79]
    s_add_u32 s74, s74, 1
    s_nop 3
    s_cbranch_vccz L_qg_done
    s_cmp_ge_u32 s74, 0x40000
    s_cbranch_scc1 L_qg_done
    s_branch L_qg
L_qg_done:
    v_add_f32 v64, v64, v80
    v_add_f32 v68, v68, v84
    v_add_f32 v72, v72, v88
    v_add_f32 v76, v76, v92
    v_add_f32 v64, v64, v72
    v_add_f32 v68, v68, v76
    v_add_f32 v64, v64, v68
    v_add_f32 v65, v65, v81
    v_add_f32 v69, v69, v85
    v_add_f32 v73, v73, v89
    v_add_f32 v77, v77, v93
    v_add_f32 v65, v65, v73
    v_add_f32 v69, v69, v77
    v_add_f32 v65, v65, v69
    v_add_f32 v66, v66, v82
    v_add_f32 v70, v70, v86
    v_add_f32 v74, v74, v90
    v_add_f32 v78, v78, v94
    v_add_f32 v66, v66, v74
    v_add_f32 v70, v70, v78
    v_add_f32 v66, v66, v70
    v_cvt_pk_bf16_f32 v64, v64, v64
    v_cvt_pk_bf16_f32 v65, v65, v65
    v_cvt_pk_bf16_f32 v66, v66, v66
    v_mul_u32_u24 v5, 6, v1
    ds_write_b16 v5, v64 offset:17664
    ds_write_b16 v5, v65 offset:17666
    ds_write_b16 v5, v66 offset:17668
    s_waitcnt lgkmcnt(0)
    s_branch L_late_stream
L_wave_h:
    v_lshlrev_b32 v5, 2, v1
    buffer_load_dword v47, v5, s[56:59], 0 offen offset:0
    buffer_load_dword v48, v5, s[56:59], 0 offen offset:256
    buffer_load_dword v49, v5, s[56:59], 0 offen offset:512
    buffer_load_dword v50, v5, s[56:59], 0 offen offset:768
    buffer_load_dword v51, v5, s[56:59], 0 offen offset:1024
    v_mul_u32_u24 v6, 3072, v1
    s_mul_i32 s72, s30, 12
    v_add_u32 v6, s72, v6
    s_mov_b32 s72, 0
    buffer_load_dwordx3 v[64:66], v6, s[48:51], s72 offen
    s_add_u32 s72, s72, 196608
    buffer_load_dwordx3 v[68:70], v6, s[48:51], s72 offen
    s_add_u32 s72, s72, 196608
    buffer_load_dwordx3 v[72:74], v6, s[48:51], s72 offen
    s_add_u32 s72, s72, 196608
    buffer_load_dwordx3 v[76:78], v6, s[48:51], s72 offen
    s_add_u32 s72, s72, 196608
    buffer_load_dwordx3 v[80:82], v6, s[48:51], s72 offen
    s_add_u32 s72, s72, 196608
    buffer_load_dwordx3 v[84:86], v6, s[48:51], s72 offen
    s_add_u32 s72, s72, 196608
    buffer_load_dwordx3 v[88:90], v6, s[48:51], s72 offen
    s_add_u32 s72, s72, 196608
    buffer_load_dwordx3 v[92:94], v6, s[48:51], s72 offen
    s_add_u32 s72, s72, 196608
    buffer_load_dwordx3 v[96:98], v6, s[48:51], s72 offen
    s_add_u32 s72, s72, 196608
    buffer_load_dwordx3 v[100:102], v6, s[48:51], s72 offen
    s_mul_i32 s72, s30, 6
    v_add_u32 v6, s72, v1
    v_lshlrev_b32 v6, 1, v6
    buffer_load_ushort v15, v6, s[60:63], 0 offen
    s_barrier
    s_waitcnt vmcnt(11)
    v_lshlrev_b32 v52, 16, v47
    v_and_b32 v53, 0xffff0000, v47
    v_lshlrev_b32 v54, 16, v48
    v_and_b32 v55, 0xffff0000, v48
    v_lshlrev_b32 v56, 16, v49
    v_and_b32 v57, 0xffff0000, v49
    v_lshlrev_b32 v58, 16, v50
    v_and_b32 v59, 0xffff0000, v50
    v_lshlrev_b32 v60, 16, v51
    v_and_b32 v61, 0xffff0000, v51
    v_add_f32 v43, v52, v53
    v_add_f32 v43, v43, v54
    v_add_f32 v43, v43, v55
    v_add_f32 v43, v43, v56
    v_add_f32 v43, v43, v57
    v_add_f32 v43, v43, v58
    v_add_f32 v43, v43, v59
    v_add_f32 v43, v43, v60
    v_add_f32 v43, v43, v61
    s_nop 1
    v_add_f32_dpp v43, v43, v43 row_shr:1 row_mask:0xf bank_mask:0xf
    s_nop 1
    v_add_f32_dpp v43, v43, v43 row_shr:2 row_mask:0xf bank_mask:0xf
    s_nop 1
    v_add_f32_dpp v43, v43, v43 row_shr:4 row_mask:0xf bank_mask:0xf
    s_nop 1
    v_add_f32_dpp v43, v43, v43 row_shr:8 row_mask:0xf bank_mask:0xf
    s_nop 1
    v_add_f32_dpp v43, v43, v43 row_bcast:15 row_mask:0xa bank_mask:0xf
    s_nop 1
    v_add_f32_dpp v43, v43, v43 row_bcast:31 row_mask:0xc bank_mask:0xf
    s_nop 0
    v_readlane_b32 s74, v43, 63
    s_nop 1
    v_mov_b32 v62, 0x3acccccd
    v_mul_f32 v62, s74, v62
    v_sub_f32 v63, v52, v62
    v_mul_f32 v43, v63, v63
    v_sub_f32 v63, v53, v62
    v_fma_f32 v43, v63, v63, v43
    v_sub_f32 v63, v54, v62
    v_fma_f32 v43, v63, v63, v43
    v_sub_f32 v63, v55, v62
    v_fma_f32 v43, v63, v63, v43
    v_sub_f32 v63, v56, v62
    v_fma_f32 v43, v63, v63, v43
    v_sub_f32 v63, v57, v62
    v_fma_f32 v43, v63, v63, v43
    v_sub_f32 v63, v58, v62
    v_fma_f32 v43, v63, v63, v43
    v_sub_f32 v63, v59, v62
    v_fma_f32 v43, v63, v63, v43
    v_sub_f32 v63, v60, v62
    v_fma_f32 v43, v63, v63, v43
    v_sub_f32 v63, v61, v62
    v_fma_f32 v43, v63, v63, v43
    s_nop 1
    v_add_f32_dpp v43, v43, v43 row_shr:1 row_mask:0xf bank_mask:0xf
    s_nop 1
    v_add_f32_dpp v43, v43, v43 row_shr:2 row_mask:0xf bank_mask:0xf
    s_nop 1
    v_add_f32_dpp v43, v43, v43 row_shr:4 row_mask:0xf bank_mask:0xf
    s_nop 1
    v_add_f32_dpp v43, v43, v43 row_shr:8 row_mask:0xf bank_mask:0xf
    s_nop 1
    v_add_f32_dpp v43, v43, v43 row_bcast:15 row_mask:0xa bank_mask:0xf
    s_nop 1
    v_add_f32_dpp v43, v43, v43 row_bcast:31 row_mask:0xc bank_mask:0xf
    s_nop 0
    v_readlane_b32 s74, v43, 63
    s_nop 1
    v_mov_b32 v63, 0x3acccccd
    v_mul_f32 v63, s74, v63
    v_cvt_pk_bf16_f32 v62, v62, v62
    v_and_b32 v62, 0xffff0000, v62
    v_cvt_pk_bf16_f32 v63, v63, v63
    v_and_b32 v63, 0xffff0000, v63
    v_add_f32 v63, 0x3727c5ac, v63
    v_cvt_pk_bf16_f32 v63, v63, v63
    v_and_b32 v63, 0xffff0000, v63
    v_sqrt_f32 v63, v63
    s_nop 0
    v_cvt_pk_bf16_f32 v63, v63, v63
    v_and_b32 v63, 0xffff0000, v63
    v_rcp_f32 v63, v63
    s_nop 0
    v_sub_f32 v52, v52, v62
    v_cvt_pk_bf16_f32 v52, v52, v52
    v_and_b32 v52, 0xffff0000, v52
    v_mul_f32 v52, v52, v63
    v_cvt_pk_bf16_f32 v52, v52, v52
    v_and_b32 v52, 0xffff0000, v52
    v_sub_f32 v53, v53, v62
    v_cvt_pk_bf16_f32 v53, v53, v53
    v_and_b32 v53, 0xffff0000, v53
    v_mul_f32 v53, v53, v63
    v_cvt_pk_bf16_f32 v53, v53, v53
    v_and_b32 v53, 0xffff0000, v53
    v_sub_f32 v54, v54, v62
    v_cvt_pk_bf16_f32 v54, v54, v54
    v_and_b32 v54, 0xffff0000, v54
    v_mul_f32 v54, v54, v63
    v_cvt_pk_bf16_f32 v54, v54, v54
    v_and_b32 v54, 0xffff0000, v54
    v_sub_f32 v55, v55, v62
    v_cvt_pk_bf16_f32 v55, v55, v55
    v_and_b32 v55, 0xffff0000, v55
    v_mul_f32 v55, v55, v63
    v_cvt_pk_bf16_f32 v55, v55, v55
    v_and_b32 v55, 0xffff0000, v55
    v_sub_f32 v56, v56, v62
    v_cvt_pk_bf16_f32 v56, v56, v56
    v_and_b32 v56, 0xffff0000, v56
    v_mul_f32 v56, v56, v63
    v_cvt_pk_bf16_f32 v56, v56, v56
    v_and_b32 v56, 0xffff0000, v56
    v_sub_f32 v57, v57, v62
    v_cvt_pk_bf16_f32 v57, v57, v57
    v_and_b32 v57, 0xffff0000, v57
    v_mul_f32 v57, v57, v63
    v_cvt_pk_bf16_f32 v57, v57, v57
    v_and_b32 v57, 0xffff0000, v57
    v_sub_f32 v58, v58, v62
    v_cvt_pk_bf16_f32 v58, v58, v58
    v_and_b32 v58, 0xffff0000, v58
    v_mul_f32 v58, v58, v63
    v_cvt_pk_bf16_f32 v58, v58, v58
    v_and_b32 v58, 0xffff0000, v58
    v_sub_f32 v59, v59, v62
    v_cvt_pk_bf16_f32 v59, v59, v59
    v_and_b32 v59, 0xffff0000, v59
    v_mul_f32 v59, v59, v63
    v_cvt_pk_bf16_f32 v59, v59, v59
    v_and_b32 v59, 0xffff0000, v59
    v_sub_f32 v60, v60, v62
    v_cvt_pk_bf16_f32 v60, v60, v60
    v_and_b32 v60, 0xffff0000, v60
    v_mul_f32 v60, v60, v63
    v_cvt_pk_bf16_f32 v60, v60, v60
    v_and_b32 v60, 0xffff0000, v60
    v_sub_f32 v61, v61, v62
    v_cvt_pk_bf16_f32 v61, v61, v61
    v_and_b32 v61, 0xffff0000, v61
    v_mul_f32 v61, v61, v63
    v_cvt_pk_bf16_f32 v61, v61, v61
    v_and_b32 v61, 0xffff0000, v61
    v_add_f32 v43, v52, v53
    v_add_f32 v43, v43, v54
    v_add_f32 v43, v43, v55
    v_add_f32 v43, v43, v56
    v_add_f32 v43, v43, v57
    v_add_f32 v43, v43, v58
    v_add_f32 v43, v43, v59
    v_add_f32 v43, v43, v60
    v_add_f32 v43, v43, v61
    s_nop 1
    v_add_f32_dpp v43, v43, v43 row_shr:1 row_mask:0xf bank_mask:0xf
    s_nop 1
    v_add_f32_dpp v43, v43, v43 row_shr:2 row_mask:0xf bank_mask:0xf
    s_nop 1
    v_add_f32_dpp v43, v43, v43 row_shr:4 row_mask:0xf bank_mask:0xf
    s_nop 1
    v_add_f32_dpp v43, v43, v43 row_shr:8 row_mask:0xf bank_mask:0xf
    s_nop 1
    v_add_f32_dpp v43, v43, v43 row_bcast:15 row_mask:0xa bank_mask:0xf
    s_nop 1
    v_add_f32_dpp v43, v43, v43 row_bcast:31 row_mask:0xc bank_mask:0xf
    s_nop 0
    v_readlane_b32 s74, v43, 63
    s_nop 1
    v_mov_b32 v62, 0x3acccccd
    v_mul_f32 v62, s74, v62
    v_sub_f32 v63, v52, v62
    v_mul_f32 v43, v63, v63
    v_sub_f32 v63, v53, v62
    v_fma_f32 v43, v63, v63, v43
    v_sub_f32 v63, v54, v62
    v_fma_f32 v43, v63, v63, v43
    v_sub_f32 v63, v55, v62
    v_fma_f32 v43, v63, v63, v43
    v_sub_f32 v63, v56, v62
    v_fma_f32 v43, v63, v63, v43
    v_sub_f32 v63, v57, v62
    v_fma_f32 v43, v63, v63, v43
    v_sub_f32 v63, v58, v62
    v_fma_f32 v43, v63, v63, v43
    v_sub_f32 v63, v59, v62
    v_fma_f32 v43, v63, v63, v43
    v_sub_f32 v63, v60, v62
    v_fma_f32 v43, v63, v63, v43
    v_sub_f32 v63, v61, v62
    v_fma_f32 v43, v63, v63, v43
    s_nop 1
    v_add_f32_dpp v43, v43, v43 row_shr:1 row_mask:0xf bank_mask:0xf
    s_nop 1
    v_add_f32_dpp v43, v43, v43 row_shr:2 row_mask:0xf bank_mask:0xf
    s_nop 1
    v_add_f32_dpp v43, v43, v43 row_shr:4 row_mask:0xf bank_mask:0xf
    s_nop 1
    v_add_f32_dpp v43, v43, v43 row_shr:8 row_mask:0xf bank_mask:0xf
    s_nop 1
    v_add_f32_dpp v43, v43, v43 row_bcast:15 row_mask:0xa bank_mask:0xf
    s_nop 1
    v_add_f32_dpp v43, v43, v43 row_bcast:31 row_mask:0xc bank_mask:0xf
    s_nop 0
    v_readlane_b32 s74, v43, 63
    s_nop 1
    v_mov_b32 v63, 0x3acccccd
    v_mul_f32 v63, s74, v63
    v_cvt_pk_bf16_f32 v62, v62, v62
    v_and_b32 v62, 0xffff0000, v62
    v_cvt_pk_bf16_f32 v63, v63, v63
    v_and_b32 v63, 0xffff0000, v63
    v_add_f32 v63, 0x3727c5ac, v63
    v_cvt_pk_bf16_f32 v63, v63, v63
    v_and_b32 v63, 0xffff0000, v63
    v_sqrt_f32 v63, v63
    s_nop 0
    v_cvt_pk_bf16_f32 v63, v63, v63
    v_and_b32 v63, 0xffff0000, v63
    v_rcp_f32 v63, v63
    s_nop 0
    v_sub_f32 v52, v52, v62
    v_cvt_pk_bf16_f32 v52, v52, v52
    v_and_b32 v52, 0xffff0000, v52
    v_mul_f32 v52, v52, v63
    v_cvt_pk_bf16_f32 v52, v52, v52
    v_and_b32 v52, 0xffff0000, v52
    v_sub_f32 v53, v53, v62
    v_cvt_pk_bf16_f32 v53, v53, v53
    v_and_b32 v53, 0xffff0000, v53
    v_mul_f32 v53, v53, v63
    v_cvt_pk_bf16_f32 v53, v53, v53
    v_and_b32 v53, 0xffff0000, v53
    v_sub_f32 v54, v54, v62
    v_cvt_pk_bf16_f32 v54, v54, v54
    v_and_b32 v54, 0xffff0000, v54
    v_mul_f32 v54, v54, v63
    v_cvt_pk_bf16_f32 v54, v54, v54
    v_and_b32 v54, 0xffff0000, v54
    v_sub_f32 v55, v55, v62
    v_cvt_pk_bf16_f32 v55, v55, v55
    v_and_b32 v55, 0xffff0000, v55
    v_mul_f32 v55, v55, v63
    v_cvt_pk_bf16_f32 v55, v55, v55
    v_and_b32 v55, 0xffff0000, v55
    v_sub_f32 v56, v56, v62
    v_cvt_pk_bf16_f32 v56, v56, v56
    v_and_b32 v56, 0xffff0000, v56
    v_mul_f32 v56, v56, v63
    v_cvt_pk_bf16_f32 v56, v56, v56
    v_and_b32 v56, 0xffff0000, v56
    v_sub_f32 v57, v57, v62
    v_cvt_pk_bf16_f32 v57, v57, v57
    v_and_b32 v57, 0xffff0000, v57
    v_mul_f32 v57, v57, v63
    v_cvt_pk_bf16_f32 v57, v57, v57
    v_and_b32 v57, 0xffff0000, v57
    v_sub_f32 v58, v58, v62
    v_cvt_pk_bf16_f32 v58, v58, v58
    v_and_b32 v58, 0xffff0000, v58
    v_mul_f32 v58, v58, v63
    v_cvt_pk_bf16_f32 v58, v58, v58
    v_and_b32 v58, 0xffff0000, v58
    v_sub_f32 v59, v59, v62
    v_cvt_pk_bf16_f32 v59, v59, v59
    v_and_b32 v59, 0xffff0000, v59
    v_mul_f32 v59, v59, v63
    v_cvt_pk_bf16_f32 v59, v59, v59
    v_and_b32 v59, 0xffff0000, v59
    v_sub_f32 v60, v60, v62
    v_cvt_pk_bf16_f32 v60, v60, v60
    v_and_b32 v60, 0xffff0000, v60
    v_mul_f32 v60, v60, v63
    v_cvt_pk_bf16_f32 v60, v60, v60
    v_and_b32 v60, 0xffff0000, v60
    v_sub_f32 v61, v61, v62
    v_cvt_pk_bf16_f32 v61, v61, v61
    v_and_b32 v61, 0xffff0000, v61
    v_mul_f32 v61, v61, v63
    v_cvt_pk_bf16_f32 v61, v61, v61
    v_and_b32 v61, 0xffff0000, v61
    v_lshlrev_b32 v5, 3, v1
    ds_write_b64 v5, v[52:53] offset:2560
    ds_write_b64 v5, v[54:55] offset:3072
    ds_write_b64 v5, v[56:57] offset:3584
    ds_write_b64 v5, v[58:59] offset:4096
    ds_write_b64 v5, v[60:61] offset:4608
    s_waitcnt lgkmcnt(0)
    v_lshlrev_b32 v5, 2, v1
    ds_read_b32 v67, v5 offset:2560
    ds_read_b32 v71, v5 offset:2816
    ds_read_b32 v75, v5 offset:3072
    ds_read_b32 v79, v5 offset:3328
    ds_read_b32 v83, v5 offset:3584
    ds_read_b32 v87, v5 offset:3840
    ds_read_b32 v91, v5 offset:4096
    ds_read_b32 v95, v5 offset:4352
    ds_read_b32 v99, v5 offset:4608
    ds_read_b32 v103, v5 offset:4864
    v_mov_b32 v16, 0
    v_mov_b32 v17, 0
    v_mov_b32 v18, 0
    v_mov_b32 v19, 0
    v_mov_b32 v20, 0
    v_mov_b32 v21, 0
    s_waitcnt vmcnt(0)
    s_waitcnt lgkmcnt(0)
    v_lshrrev_b32 v14, 16, v67
    v_dot2_f32_bf16 v16, v64, v14, v16
    v_dot2_f32_bf16 v17, v64, v67, v17
    v_dot2_f32_bf16 v18, v65, v14, v18
    v_dot2_f32_bf16 v19, v65, v67, v19
    v_dot2_f32_bf16 v20, v66, v14, v20
    v_dot2_f32_bf16 v21, v66, v67, v21
    v_lshrrev_b32 v14, 16, v71
    v_dot2_f32_bf16 v16, v68, v14, v16
    v_dot2_f32_bf16 v17, v68, v71, v17
    v_dot2_f32_bf16 v18, v69, v14, v18
    v_dot2_f32_bf16 v19, v69, v71, v19
    v_dot2_f32_bf16 v20, v70, v14, v20
    v_dot2_f32_bf16 v21, v70, v71, v21
    v_lshrrev_b32 v14, 16, v75
    v_dot2_f32_bf16 v16, v72, v14, v16
    v_dot2_f32_bf16 v17, v72, v75, v17
    v_dot2_f32_bf16 v18, v73, v14, v18
    v_dot2_f32_bf16 v19, v73, v75, v19
    v_dot2_f32_bf16 v20, v74, v14, v20
    v_dot2_f32_bf16 v21, v74, v75, v21
    v_lshrrev_b32 v14, 16, v79
    v_dot2_f32_bf16 v16, v76, v14, v16
    v_dot2_f32_bf16 v17, v76, v79, v17
    v_dot2_f32_bf16 v18, v77, v14, v18
    v_dot2_f32_bf16 v19, v77, v79, v19
    v_dot2_f32_bf16 v20, v78, v14, v20
    v_dot2_f32_bf16 v21, v78, v79, v21
    v_lshrrev_b32 v14, 16, v83
    v_dot2_f32_bf16 v16, v80, v14, v16
    v_dot2_f32_bf16 v17, v80, v83, v17
    v_dot2_f32_bf16 v18, v81, v14, v18
    v_dot2_f32_bf16 v19, v81, v83, v19
    v_dot2_f32_bf16 v20, v82, v14, v20
    v_dot2_f32_bf16 v21, v82, v83, v21
    v_lshrrev_b32 v14, 16, v87
    v_dot2_f32_bf16 v16, v84, v14, v16
    v_dot2_f32_bf16 v17, v84, v87, v17
    v_dot2_f32_bf16 v18, v85, v14, v18
    v_dot2_f32_bf16 v19, v85, v87, v19
    v_dot2_f32_bf16 v20, v86, v14, v20
    v_dot2_f32_bf16 v21, v86, v87, v21
    v_lshrrev_b32 v14, 16, v91
    v_dot2_f32_bf16 v16, v88, v14, v16
    v_dot2_f32_bf16 v17, v88, v91, v17
    v_dot2_f32_bf16 v18, v89, v14, v18
    v_dot2_f32_bf16 v19, v89, v91, v19
    v_dot2_f32_bf16 v20, v90, v14, v20
    v_dot2_f32_bf16 v21, v90, v91, v21
    v_lshrrev_b32 v14, 16, v95
    v_dot2_f32_bf16 v16, v92, v14, v16
    v_dot2_f32_bf16 v17, v92, v95, v17
    v_dot2_f32_bf16 v18, v93, v14, v18
    v_dot2_f32_bf16 v19, v93, v95, v19
    v_dot2_f32_bf16 v20, v94, v14, v20
    v_dot2_f32_bf16 v21, v94, v95, v21
    v_lshrrev_b32 v14, 16, v99
    v_dot2_f32_bf16 v16, v96, v14, v16
    v_dot2_f32_bf16 v17, v96, v99, v17
    v_dot2_f32_bf16 v18, v97, v14, v18
    v_dot2_f32_bf16 v19, v97, v99, v19
    v_dot2_f32_bf16 v20, v98, v14, v20
    v_dot2_f32_bf16 v21, v98, v99, v21
    v_lshrrev_b32 v14, 16, v103
    v_dot2_f32_bf16 v16, v100, v14, v16
    v_dot2_f32_bf16 v17, v100, v103, v17
    v_dot2_f32_bf16 v18, v101, v14, v18
    v_dot2_f32_bf16 v19, v101, v103, v19
    v_dot2_f32_bf16 v20, v102, v14, v20
    v_dot2_f32_bf16 v21, v102, v103, v21
    s_nop 3
    v_add_f32_dpp v16, v16, v16 row_shr:1 row_mask:0xf bank_mask:0xf
    v_add_f32_dpp v17, v17, v17 row_shr:1 row_mask:0xf bank_mask:0xf
    v_add_f32_dpp v18, v18, v18 row_shr:1 row_mask:0xf bank_mask:0xf
    v_add_f32_dpp v19, v19, v19 row_shr:1 row_mask:0xf bank_mask:0xf
    v_add_f32_dpp v20, v20, v20 row_shr:1 row_mask:0xf bank_mask:0xf
    v_add_f32_dpp v21, v21, v21 row_shr:1 row_mask:0xf bank_mask:0xf
    v_add_f32_dpp v16, v16, v16 row_shr:2 row_mask:0xf bank_mask:0xf
    v_add_f32_dpp v17, v17, v17 row_shr:2 row_mask:0xf bank_mask:0xf
    v_add_f32_dpp v18, v18, v18 row_shr:2 row_mask:0xf bank_mask:0xf
    v_add_f32_dpp v19, v19, v19 row_shr:2 row_mask:0xf bank_mask:0xf
    v_add_f32_dpp v20, v20, v20 row_shr:2 row_mask:0xf bank_mask:0xf
    v_add_f32_dpp v21, v21, v21 row_shr:2 row_mask:0xf bank_mask:0xf
    v_add_f32_dpp v16, v16, v16 row_shr:4 row_mask:0xf bank_mask:0xf
    v_add_f32_dpp v17, v17, v17 row_shr:4 row_mask:0xf bank_mask:0xf
    v_add_f32_dpp v18, v18, v18 row_shr:4 row_mask:0xf bank_mask:0xf
    v_add_f32_dpp v19, v19, v19 row_shr:4 row_mask:0xf bank_mask:0xf
    v_add_f32_dpp v20, v20, v20 row_shr:4 row_mask:0xf bank_mask:0xf
    v_add_f32_dpp v21, v21, v21 row_shr:4 row_mask:0xf bank_mask:0xf
    v_add_f32_dpp v16, v16, v16 row_shr:8 row_mask:0xf bank_mask:0xf
    v_add_f32_dpp v17, v17, v17 row_shr:8 row_mask:0xf bank_mask:0xf
    v_add_f32_dpp v18, v18, v18 row_shr:8 row_mask:0xf bank_mask:0xf
    v_add_f32_dpp v19, v19, v19 row_shr:8 row_mask:0xf bank_mask:0xf
    v_add_f32_dpp v20, v20, v20 row_shr:8 row_mask:0xf bank_mask:0xf
    v_add_f32_dpp v21, v21, v21 row_shr:8 row_mask:0xf bank_mask:0xf
    v_add_f32_dpp v16, v16, v16 row_bcast:15 row_mask:0xa bank_mask:0xf
    v_add_f32_dpp v17, v17, v17 row_bcast:15 row_mask:0xa bank_mask:0xf
    v_add_f32_dpp v18, v18, v18 row_bcast:15 row_mask:0xa bank_mask:0xf
    v_add_f32_dpp v19, v19, v19 row_bcast:15 row_mask:0xa bank_mask:0xf
    v_add_f32_dpp v20, v20, v20 row_bcast:15 row_mask:0xa bank_mask:0xf
    v_add_f32_dpp v21, v21, v21 row_bcast:15 row_mask:0xa bank_mask:0xf
    v_add_f32_dpp v16, v16, v16 row_bcast:31 row_mask:0xc bank_mask:0xf
    v_add_f32_dpp v17, v17, v17 row_bcast:31 row_mask:0xc bank_mask:0xf
    v_add_f32_dpp v18, v18, v18 row_bcast:31 row_mask:0xc bank_mask:0xf
    v_add_f32_dpp v19, v19, v19 row_bcast:31 row_mask:0xc bank_mask:0xf
    v_add_f32_dpp v20, v20, v20 row_bcast:31 row_mask:0xc bank_mask:0xf
    v_add_f32_dpp v21, v21, v21 row_bcast:31 row_mask:0xc bank_mask:0xf
    v_mov_b32 v5, 0
    s_mov_b32 exec_lo, 0
    s_mov_b32 exec_hi, 0x80000000
    ds_write_b64 v5, v[16:17] offset:17408
    ds_write_b64 v5, v[18:19] offset:17416
    ds_write_b64 v5, v[20:21] offset:17424
    s_mov_b32 exec_lo, 0x3f
    s_mov_b32 exec_hi, 0
    v_lshlrev_b32 v5, 2, v1
    s_waitcnt lgkmcnt(0)
    ds_read_b32 v40, v5 offset:17408
    s_waitcnt lgkmcnt(0)
    v_cvt_pk_bf16_f32 v40, v40, v40
    v_and_b32 v40, 0xffff0000, v40
    v_lshlrev_b32 v41, 16, v15
    v_add_f32 v40, v40, v41
    v_cvt_pk_bf16_f32 v40, v40, v40
    v_and_b32 v40, 0xffff0000, v40
    v_mul_f32 v41, v40, v40
    v_mov_b32 v42, 0x3d372713
    v_fma_f32 v41, v41, v42, 1.0
    v_mul_f32 v41, v41, v40
    v_mul_f32 v41, 0x40135761, v41
    v_exp_f32 v41, v41
    s_nop 0
    v_add_f32 v41, 1.0, v41
    v_rcp_f32 v41, v41
    s_nop 0
    v_fma_f32 v40, -v40, v41, v40
    v_cvt_pk_bf16_f32 v40, v40, v40
    v_and_b32 v40, 0xffff0000, v40
    ds_write_b32 v5, v40 offset:18048
    s_mov_b64 exec, -1
    s_waitcnt vmcnt(0) lgkmcnt(0)
    s_add_u32 s72, s73, 0
    buffer_load_dwordx4 v[64:67], v2, s[32:35], s72 offen offset:0 nt
    s_add_u32 s72, s73, 0
    buffer_load_dwordx4 v[68:71], v2, s[32:35], s72 offen offset:128 nt
    s_add_u32 s72, s73, 0
    buffer_load_dwordx4 v[72:75], v2, s[32:35], s72 offen offset:256 nt
    s_add_u32 s72, s73, 3072
    buffer_load_dwordx4 v[76:79], v2, s[32:35], s72 offen offset:0 nt
    s_add_u32 s72, s73, 3072
    buffer_load_dwordx4 v[80:83], v2, s[32:35], s72 offen offset:128 nt
    s_add_u32 s72, s73, 3072
    buffer_load_dwordx4 v[84:87], v2, s[32:35], s72 offen offset:256 nt
    s_add_u32 s72, s73, 6144
    buffer_load_dwordx4 v[88:91], v2, s[32:35], s72 offen offset:0 nt
    s_add_u32 s72, s73, 6144
    buffer_load_dwordx4 v[92:95], v2, s[32:35], s72 offen offset:128 nt
    s_add_u32 s72, s73, 6144
    buffer_load_dwordx4 v[96:99], v2, s[32:35], s72 offen offset:256 nt
    s_add_u32 s72, s73, 9216
    buffer_load_dwordx4 v[100:103], v2, s[32:35], s72 offen offset:0 nt
    s_add_u32 s72, s73, 9216
    buffer_load_dwordx4 v[104:107], v2, s[32:35], s72 offen offset:128 nt
    s_add_u32 s72, s73, 9216
    buffer_load_dwordx4 v[108:111], v2, s[32:35], s72 offen offset:256 nt
    s_add_u32 s72, s73, 12288
    buffer_load_dwordx4 v[112:115], v2, s[32:35], s72 offen offset:0 nt
    s_add_u32 s72, s73, 12288
    buffer_load_dwordx4 v[116:119], v2, s[32:35], s72 offen offset:128 nt
    s_add_u32 s72, s73, 12288
    buffer_load_dwordx4 v[120:123], v2, s[32:35], s72 offen offset:256 nt
    s_add_u32 s72, s73, 15360
    buffer_load_dwordx4 v[124:127], v2, s[32:35], s72 offen offset:0 nt
    s_add_u32 s72, s73, 15360
    buffer_load_dwordx4 v[128:131], v2, s[32:35], s72 offen offset:128 nt
    s_add_u32 s72, s73, 15360
    buffer_load_dwordx4 v[132:135], v2, s[32:35], s72 offen offset:256 nt
    s_add_u32 s72, s73, 18432
    buffer_load_dwordx4 v[136:139], v2, s[32:35], s72 offen offset:0 nt
    s_add_u32 s72, s73, 18432
    buffer_load_dwordx4 v[140:143], v2, s[32:35], s72 offen offset:128 nt
    s_add_u32 s72, s73, 18432
    buffer_load_dwordx4 v[144:147], v2, s[32:35], s72 offen offset:256 nt
    s_add_u32 s72, s73, 21504
    buffer_load_dwordx4 v[148:151], v2, s[32:35], s72 offen offset:0 nt
    s_add_u32 s72, s73, 21504
    buffer_load_dwordx4 v[152:155], v2, s[32:35], s72 offen offset:128 nt
    s_add_u32 s72, s73, 21504
    buffer_load_dwordx4 v[156:159], v2, s[32:35], s72 offen offset:256 nt
    s_add_u32 s72, s73, 0
    buffer_load_dwordx3 v[160:162], v3, s[36:39], s72 offen nt
    s_add_u32 s72, s73, 768
    buffer_load_dwordx3 v[164:166], v3, s[36:39], s72 offen nt
    s_add_u32 s72, s73, 1536
    buffer_load_dwordx3 v[168:170], v3, s[36:39], s72 offen nt
    s_add_u32 s72, s73, 2304
    buffer_load_dwordx3 v[172:174], v3, s[36:39], s72 offen nt
    s_add_u32 s72, s73, 3072
    buffer_load_dwordx3 v[176:178], v3, s[36:39], s72 offen nt
    s_add_u32 s72, s73, 3840
    buffer_load_dwordx3 v[180:182], v3, s[36:39], s72 offen nt
    s_add_u32 s72, s73, 4608
    buffer_load_dwordx3 v[184:186], v3, s[36:39], s72 offen nt
    s_add_u32 s72, s73, 5376
    buffer_load_dwordx3 v[188:190], v3, s[36:39], s72 offen nt
    s_add_u32 s72, s73, 6144
    buffer_load_dwordx3 v[192:194], v3, s[36:39], s72 offen nt
    s_add_u32 s72, s73, 6912
    buffer_load_dwordx3 v[196:198], v3, s[36:39], s72 offen nt
    s_add_u32 s72, s73, 7680
    buffer_load_dwordx3 v[200:202], v3, s[36:39], s72 offen nt
    s_add_u32 s72, s73, 8448
    buffer_load_dwordx3 v[204:206], v3, s[36:39], s72 offen nt
    s_add_u32 s72, s73, 9216
    buffer_load_dwordx3 v[208:210], v3, s[36:39], s72 offen nt
    s_add_u32 s72, s73, 9984
    buffer_load_dwordx3 v[212:214], v3, s[36:39], s72 offen nt
    s_add_u32 s72, s73, 10752
    buffer_load_dwordx3 v[216:218], v3, s[36:39], s72 offen nt
    s_add_u32 s72, s73, 11520
    buffer_load_dwordx3 v[220:222], v3, s[36:39], s72 offen nt
    s_add_u32 s72, s73, 12288
    buffer_load_dwordx3 v[224:226], v3, s[36:39], s72 offen nt
    s_add_u32 s72, s73, 13056
    buffer_load_dwordx3 v[228:230], v3, s[36:39], s72 offen nt
    s_add_u32 s72, s73, 13824
    buffer_load_dwordx3 v[232:234], v3, s[36:39], s72 offen nt
    s_add_u32 s72, s73, 14592
    buffer_load_dwordx3 v[236:238], v3, s[36:39], s72 offen nt
    s_add_u32 s72, s73, 15360
    buffer_load_dwordx3 v[240:242], v3, s[36:39], s72 offen nt
    s_add_u32 s72, s73, 16128
    buffer_load_dwordx3 v[244:246], v3, s[36:39], s72 offen nt
    s_add_u32 s72, s73, 16896
    buffer_load_dwordx3 v[248:250], v3, s[36:39], s72 offen nt
    s_add_u32 s72, s73, 17664
    buffer_load_dwordx3 v[252:254], v3, s[36:39], s72 offen nt
    s_barrier
    s_branch L_join
L_late_stream:
    s_barrier
    s_setprio 0
    s_waitcnt vmcnt(0)
    s_add_u32 s72, s73, 0
    buffer_load_dwordx4 v[64:67], v2, s[32:35], s72 offen offset:0 nt
    s_add_u32 s72, s73, 0
    buffer_load_dwordx4 v[68:71], v2, s[32:35], s72 offen offset:128 nt
    s_add_u32 s72, s73, 0
    buffer_load_dwordx4 v[72:75], v2, s[32:35], s72 offen offset:256 nt
    s_add_u32 s72, s73, 3072
    buffer_load_dwordx4 v[76:79], v2, s[32:35], s72 offen offset:0 nt
    s_add_u32 s72, s73, 3072
    buffer_load_dwordx4 v[80:83], v2, s[32:35], s72 offen offset:128 nt
    s_add_u32 s72, s73, 3072
    buffer_load_dwordx4 v[84:87], v2, s[32:35], s72 offen offset:256 nt
    s_add_u32 s72, s73, 6144
    buffer_load_dwordx4 v[88:91], v2, s[32:35], s72 offen offset:0 nt
    s_add_u32 s72, s73, 6144
    buffer_load_dwordx4 v[92:95], v2, s[32:35], s72 offen offset:128 nt
    s_add_u32 s72, s73, 6144
    buffer_load_dwordx4 v[96:99], v2, s[32:35], s72 offen offset:256 nt
    s_add_u32 s72, s73, 9216
    buffer_load_dwordx4 v[100:103], v2, s[32:35], s72 offen offset:0 nt
    s_add_u32 s72, s73, 9216
    buffer_load_dwordx4 v[104:107], v2, s[32:35], s72 offen offset:128 nt
    s_add_u32 s72, s73, 9216
    buffer_load_dwordx4 v[108:111], v2, s[32:35], s72 offen offset:256 nt
    s_add_u32 s72, s73, 12288
    buffer_load_dwordx4 v[112:115], v2, s[32:35], s72 offen offset:0 nt
    s_add_u32 s72, s73, 12288
    buffer_load_dwordx4 v[116:119], v2, s[32:35], s72 offen offset:128 nt
    s_add_u32 s72, s73, 12288
    buffer_load_dwordx4 v[120:123], v2, s[32:35], s72 offen offset:256 nt
    s_add_u32 s72, s73, 15360
    buffer_load_dwordx4 v[124:127], v2, s[32:35], s72 offen offset:0 nt
    s_add_u32 s72, s73, 15360
    buffer_load_dwordx4 v[128:131], v2, s[32:35], s72 offen offset:128 nt
    s_add_u32 s72, s73, 15360
    buffer_load_dwordx4 v[132:135], v2, s[32:35], s72 offen offset:256 nt
    s_add_u32 s72, s73, 18432
    buffer_load_dwordx4 v[136:139], v2, s[32:35], s72 offen offset:0 nt
    s_add_u32 s72, s73, 18432
    buffer_load_dwordx4 v[140:143], v2, s[32:35], s72 offen offset:128 nt
    s_add_u32 s72, s73, 18432
    buffer_load_dwordx4 v[144:147], v2, s[32:35], s72 offen offset:256 nt
    s_add_u32 s72, s73, 21504
    buffer_load_dwordx4 v[148:151], v2, s[32:35], s72 offen offset:0 nt
    s_add_u32 s72, s73, 21504
    buffer_load_dwordx4 v[152:155], v2, s[32:35], s72 offen offset:128 nt
    s_add_u32 s72, s73, 21504
    buffer_load_dwordx4 v[156:159], v2, s[32:35], s72 offen offset:256 nt
    s_add_u32 s72, s73, 0
    buffer_load_dwordx3 v[160:162], v3, s[36:39], s72 offen nt
    s_add_u32 s72, s73, 768
    buffer_load_dwordx3 v[164:166], v3, s[36:39], s72 offen nt
    s_add_u32 s72, s73, 1536
    buffer_load_dwordx3 v[168:170], v3, s[36:39], s72 offen nt
    s_add_u32 s72, s73, 2304
    buffer_load_dwordx3 v[172:174], v3, s[36:39], s72 offen nt
    s_add_u32 s72, s73, 3072
    buffer_load_dwordx3 v[176:178], v3, s[36:39], s72 offen nt
    s_add_u32 s72, s73, 3840
    buffer_load_dwordx3 v[180:182], v3, s[36:39], s72 offen nt
    s_add_u32 s72, s73, 4608
    buffer_load_dwordx3 v[184:186], v3, s[36:39], s72 offen nt
    s_add_u32 s72, s73, 5376
    buffer_load_dwordx3 v[188:190], v3, s[36:39], s72 offen nt
    s_add_u32 s72, s73, 6144
    buffer_load_dwordx3 v[192:194], v3, s[36:39], s72 offen nt
    s_add_u32 s72, s73, 6912
    buffer_load_dwordx3 v[196:198], v3, s[36:39], s72 offen nt
    s_add_u32 s72, s73, 7680
    buffer_load_dwordx3 v[200:202], v3, s[36:39], s72 offen nt
    s_add_u32 s72, s73, 8448
    buffer_load_dwordx3 v[204:206], v3, s[36:39], s72 offen nt
    s_add_u32 s72, s73, 9216
    buffer_load_dwordx3 v[208:210], v3, s[36:39], s72 offen nt
    s_add_u32 s72, s73, 9984
    buffer_load_dwordx3 v[212:214], v3, s[36:39], s72 offen nt
    s_add_u32 s72, s73, 10752
    buffer_load_dwordx3 v[216:218], v3, s[36:39], s72 offen nt
    s_add_u32 s72, s73, 11520
    buffer_load_dwordx3 v[220:222], v3, s[36:39], s72 offen nt
    s_add_u32 s72, s73, 12288
    buffer_load_dwordx3 v[224:226], v3, s[36:39], s72 offen nt
    s_add_u32 s72, s73, 13056
    buffer_load_dwordx3 v[228:230], v3, s[36:39], s72 offen nt
    s_add_u32 s72, s73, 13824
    buffer_load_dwordx3 v[232:234], v3, s[36:39], s72 offen nt
    s_add_u32 s72, s73, 14592
    buffer_load_dwordx3 v[236:238], v3, s[36:39], s72 offen nt
    s_add_u32 s72, s73, 15360
    buffer_load_dwordx3 v[240:242], v3, s[36:39], s72 offen nt
    s_add_u32 s72, s73, 16128
    buffer_load_dwordx3 v[244:246], v3, s[36:39], s72 offen nt
    s_add_u32 s72, s73, 16896
    buffer_load_dwordx3 v[248:250], v3, s[36:39], s72 offen nt
    s_add_u32 s72, s73, 17664
    buffer_load_dwordx3 v[252:254], v3, s[36:39], s72 offen nt
L_join:
    v_mov_b32 v5, 0
    ds_read_b32 v6, v5 offset:18400
    v_lshrrev_b32 v5, 4, v1
    v_lshlrev_b32 v5, 1, v5
    v_and_b32 v7, 1, v1
    v_add_u32 v5, v5, v7
    v_lshlrev_b32 v5, 4, v5
    ds_read_b128 v[16:19], v5 offset:17664
    ds_read_b128 v[20:23], v5 offset:17792
    ds_read_b128 v[24:27], v5 offset:17920
    v_lshrrev_b32 v5, 5, v1
    v_lshlrev_b32 v5, 2, v5
    v_mov_b32 v56, 0
    v_mov_b32 v57, 0
    v_mov_b32 v58, 0
    v_mov_b32 v59, 0
    v_mov_b32 v60, 0
    v_mov_b32 v61, 0
    s_waitcnt lgkmcnt(0)
    v_readfirstlane_b32 s86, v6
    s_nop 2
    s_waitcnt vmcnt(45)
    v_mfma_f32_16x16x32_bf16 v[40:43], v[16:19], v[64:67], 0
    v_mfma_f32_16x16x32_bf16 v[40:43], v[20:23], v[68:71], v[40:43]
    v_mfma_f32_16x16x32_bf16 v[40:43], v[24:27], v[72:75], v[40:43]
    s_add_u32 s72, s73, 18432
    buffer_load_dwordx3 v[64:66], v3, s[36:39], s72 offen nt
    s_add_u32 s72, s73, 19200
    buffer_load_dwordx3 v[68:70], v3, s[36:39], s72 offen nt
    s_add_u32 s72, s73, 19968
    buffer_load_dwordx3 v[72:74], v3, s[36:39], s72 offen nt
    s_waitcnt vmcnt(45)
    v_mfma_f32_16x16x32_bf16 v[44:47], v[16:19], v[76:79], 0
    v_mfma_f32_16x16x32_bf16 v[44:47], v[20:23], v[80:83], v[44:47]
    v_mfma_f32_16x16x32_bf16 v[44:47], v[24:27], v[84:87], v[44:47]
    s_add_u32 s72, s73, 20736
    buffer_load_dwordx3 v[76:78], v3, s[36:39], s72 offen nt
    s_add_u32 s72, s73, 21504
    buffer_load_dwordx3 v[80:82], v3, s[36:39], s72 offen nt
    s_add_u32 s72, s73, 22272
    buffer_load_dwordx3 v[84:86], v3, s[36:39], s72 offen nt
    s_waitcnt vmcnt(45)
    v_mfma_f32_16x16x32_bf16 v[48:51], v[16:19], v[88:91], 0
    v_mfma_f32_16x16x32_bf16 v[48:51], v[20:23], v[92:95], v[48:51]
    v_mfma_f32_16x16x32_bf16 v[48:51], v[24:27], v[96:99], v[48:51]
    s_add_u32 s72, s73, 23040
    buffer_load_dwordx3 v[88:90], v3, s[36:39], s72 offen nt
    s_add_u32 s72, s73, 23808
    buffer_load_dwordx3 v[92:94], v3, s[36:39], s72 offen nt
    s_add_u32 s72, s73, 24576
    buffer_load_dwordx4 v[96:99], v2, s[32:35], s72 offen offset:0 nt
    s_waitcnt vmcnt(45)
    v_mfma_f32_16x16x32_bf16 v[52:55], v[16:19], v[100:103], 0
    v_mfma_f32_16x16x32_bf16 v[52:55], v[20:23], v[104:107], v[52:55]
    v_mfma_f32_16x16x32_bf16 v[52:55], v[24:27], v[108:111], v[52:55]
    s_add_u32 s72, s73, 24576
    buffer_load_dwordx4 v[100:103], v2, s[32:35], s72 offen offset:128 nt
    s_add_u32 s72, s73, 24576
    buffer_load_dwordx4 v[104:107], v2, s[32:35], s72 offen offset:256 nt
    s_add_u32 s72, s73, 27648
    buffer_load_dwordx4 v[108:111], v2, s[32:35], s72 offen offset:0 nt
    s_nop 9
    v_cndmask_b32 v40, v40, v41, s[20:21]
    v_cndmask_b32 v44, v44, v45, s[20:21]
    v_cndmask_b32 v48, v48, v49, s[20:21]
    v_cndmask_b32 v52, v52, v53, s[20:21]
    s_nop 0
    v_add_f32_dpp v41, v40, v40 row_ror:8 row_mask:0xf bank_mask:0xf
    v_add_f32_dpp v45, v44, v44 row_ror:8 row_mask:0xf bank_mask:0xf
    v_add_f32_dpp v49, v48, v48 row_ror:8 row_mask:0xf bank_mask:0xf
    v_add_f32_dpp v53, v52, v52 row_ror:8 row_mask:0xf bank_mask:0xf
    v_mov_b32 v62, v41
    v_cndmask_b32 v62, v62, v45, s[6:7]
    v_cndmask_b32 v62, v62, v49, s[8:9]
    v_cndmask_b32 v62, v62, v53, s[10:11]
    s_waitcnt vmcnt(45)
    v_mfma_f32_16x16x32_bf16 v[40:43], v[16:19], v[112:115], 0
    v_mfma_f32_16x16x32_bf16 v[40:43], v[20:23], v[116:119], v[40:43]
    v_mfma_f32_16x16x32_bf16 v[40:43], v[24:27], v[120:123], v[40:43]
    s_add_u32 s72, s73, 27648
    buffer_load_dwordx4 v[112:115], v2, s[32:35], s72 offen offset:128 nt
    s_add_u32 s72, s73, 27648
    buffer_load_dwordx4 v[116:119], v2, s[32:35], s72 offen offset:256 nt
    s_add_u32 s72, s73, 30720
    buffer_load_dwordx4 v[120:123], v2, s[32:35], s72 offen offset:0 nt
    s_waitcnt vmcnt(45)
    v_mfma_f32_16x16x32_bf16 v[44:47], v[16:19], v[124:127], 0
    v_mfma_f32_16x16x32_bf16 v[44:47], v[20:23], v[128:131], v[44:47]
    v_mfma_f32_16x16x32_bf16 v[44:47], v[24:27], v[132:135], v[44:47]
    s_add_u32 s72, s73, 30720
    buffer_load_dwordx4 v[124:127], v2, s[32:35], s72 offen offset:128 nt
    s_add_u32 s72, s73, 30720
    buffer_load_dwordx4 v[128:131], v2, s[32:35], s72 offen offset:256 nt
    s_add_u32 s72, s73, 33792
    buffer_load_dwordx4 v[132:135], v2, s[32:35], s72 offen offset:0 nt
    s_waitcnt vmcnt(45)
    v_mfma_f32_16x16x32_bf16 v[48:51], v[16:19], v[136:139], 0
    v_mfma_f32_16x16x32_bf16 v[48:51], v[20:23], v[140:143], v[48:51]
    v_mfma_f32_16x16x32_bf16 v[48:51], v[24:27], v[144:147], v[48:51]
    s_add_u32 s72, s73, 33792
    buffer_load_dwordx4 v[136:139], v2, s[32:35], s72 offen offset:128 nt
    s_add_u32 s72, s73, 33792
    buffer_load_dwordx4 v[140:143], v2, s[32:35], s72 offen offset:256 nt
    s_add_u32 s72, s73, 36864
    buffer_load_dwordx4 v[144:147], v2, s[32:35], s72 offen offset:0 nt
    s_waitcnt vmcnt(45)
    v_mfma_f32_16x16x32_bf16 v[52:55], v[16:19], v[148:151], 0
    v_mfma_f32_16x16x32_bf16 v[52:55], v[20:23], v[152:155], v[52:55]
    v_mfma_f32_16x16x32_bf16 v[52:55], v[24:27], v[156:159], v[52:55]
    s_add_u32 s72, s73, 36864
    buffer_load_dwordx4 v[148:151], v2, s[32:35], s72 offen offset:128 nt
    s_add_u32 s72, s73, 36864
    buffer_load_dwordx4 v[152:155], v2, s[32:35], s72 offen offset:256 nt
    s_add_u32 s72, s73, 39936
    buffer_load_dwordx4 v[156:159], v2, s[32:35], s72 offen offset:0 nt
    s_nop 9
    v_cndmask_b32 v40, v40, v41, s[20:21]
    v_cndmask_b32 v44, v44, v45, s[20:21]
    v_cndmask_b32 v48, v48, v49, s[20:21]
    v_cndmask_b32 v52, v52, v53, s[20:21]
    s_nop 0
    v_add_f32_dpp v41, v40, v40 row_ror:8 row_mask:0xf bank_mask:0xf
    v_add_f32_dpp v45, v44, v44 row_ror:8 row_mask:0xf bank_mask:0xf
    v_add_f32_dpp v49, v48, v48 row_ror:8 row_mask:0xf bank_mask:0xf
    v_add_f32_dpp v53, v52, v52 row_ror:8 row_mask:0xf bank_mask:0xf
    v_cndmask_b32 v62, v62, v41, s[12:13]
    v_cndmask_b32 v62, v62, v45, s[14:15]
    v_cndmask_b32 v62, v62, v49, s[16:17]
    v_cndmask_b32 v62, v62, v53, s[18:19]
    v_cvt_pk_bf16_f32 v62, v62, v62
    v_and_b32 v62, 0xffff0000, v62
    v_mul_f32 v62, 0x3d93cd3a, v62
    v_cvt_pk_bf16_f32 v62, v62, v62
    v_and_b32 v62, 0xffff0000, v62
    v_mov_b32 v63, v62
    s_nop 1
    v_max_f32_dpp v63, v63, v63 row_shr:1 row_mask:0xf bank_mask:0xf
    s_nop 1
    v_max_f32_dpp v63, v63, v63 row_shr:2 row_mask:0xf bank_mask:0xf
    s_nop 1
    v_max_f32_dpp v63, v63, v63 row_shr:4 row_mask:0xf bank_mask:0xf
    s_nop 1
    v_max_f32_dpp v63, v63, v63 row_shr:8 row_mask:0xf bank_mask:0xf
    s_nop 1
    v_max_f32_dpp v63, v63, v63 row_bcast:15 row_mask:0xa bank_mask:0xf
    s_nop 1
    v_max_f32_dpp v63, v63, v63 row_bcast:31 row_mask:0xc bank_mask:0xf
    s_nop 0
    v_readlane_b32 s76, v63, 63
    s_nop 1
    s_mov_b32 s77, s76
    v_subrev_f32 v62, s77, v62
    v_mul_f32 v62, 0x3fb8aa3b, v62
    v_exp_f32 v62, v62
    s_nop 0
    v_mov_b32 v12, v62
    v_cvt_pk_bf16_f32 v62, v62, v62
    v_and_b32 v62, 0xffff0000, v62
    ds_bpermute_b32 v163, v5, v62 offset:0
    ds_bpermute_b32 v167, v5, v62 offset:8
    ds_bpermute_b32 v171, v5, v62 offset:16
    ds_bpermute_b32 v175, v5, v62 offset:24
    ds_bpermute_b32 v179, v5, v62 offset:32
    ds_bpermute_b32 v183, v5, v62 offset:40
    ds_bpermute_b32 v187, v5, v62 offset:48
    ds_bpermute_b32 v191, v5, v62 offset:56
    s_waitcnt lgkmcnt(0)
    ds_bpermute_b32 v195, v5, v62 offset:64
    ds_bpermute_b32 v199, v5, v62 offset:72
    ds_bpermute_b32 v203, v5, v62 offset:80
    ds_bpermute_b32 v207, v5, v62 offset:88
    ds_bpermute_b32 v211, v5, v62 offset:96
    ds_bpermute_b32 v215, v5, v62 offset:104
    ds_bpermute_b32 v219, v5, v62 offset:112
    ds_bpermute_b32 v223, v5, v62 offset:120
    s_waitcnt lgkmcnt(0)
    ds_bpermute_b32 v227, v5, v62 offset:128
    ds_bpermute_b32 v231, v5, v62 offset:136
    ds_bpermute_b32 v235, v5, v62 offset:144
    ds_bpermute_b32 v239, v5, v62 offset:152
    ds_bpermute_b32 v243, v5, v62 offset:160
    ds_bpermute_b32 v247, v5, v62 offset:168
    ds_bpermute_b32 v251, v5, v62 offset:176
    ds_bpermute_b32 v255, v5, v62 offset:184
    s_waitcnt lgkmcnt(0)
    ds_bpermute_b32 v67, v5, v62 offset:192
    ds_bpermute_b32 v71, v5, v62 offset:200
    ds_bpermute_b32 v75, v5, v62 offset:208
    ds_bpermute_b32 v79, v5, v62 offset:216
    ds_bpermute_b32 v83, v5, v62 offset:224
    ds_bpermute_b32 v87, v5, v62 offset:232
    ds_bpermute_b32 v91, v5, v62 offset:240
    ds_bpermute_b32 v95, v5, v62 offset:248
    s_waitcnt lgkmcnt(0)
    s_waitcnt vmcnt(46)
    v_lshrrev_b32 v14, 16, v163
    v_dot2_f32_bf16 v56, v160, v14, v56
    v_dot2_f32_bf16 v57, v160, v163, v57
    v_dot2_f32_bf16 v58, v161, v14, v58
    v_dot2_f32_bf16 v59, v161, v163, v59
    v_dot2_f32_bf16 v60, v162, v14, v60
    v_dot2_f32_bf16 v61, v162, v163, v61
    v_lshrrev_b32 v14, 16, v167
    v_dot2_f32_bf16 v56, v164, v14, v56
    v_dot2_f32_bf16 v57, v164, v167, v57
    v_dot2_f32_bf16 v58, v165, v14, v58
    v_dot2_f32_bf16 v59, v165, v167, v59
    v_dot2_f32_bf16 v60, v166, v14, v60
    v_dot2_f32_bf16 v61, v166, v167, v61
    s_add_u32 s72, s73, 39936
    buffer_load_dwordx4 v[160:163], v2, s[32:35], s72 offen offset:128 nt
    s_add_u32 s72, s73, 39936
    buffer_load_dwordx4 v[164:167], v2, s[32:35], s72 offen offset:256 nt
    s_waitcnt vmcnt(46)
    v_lshrrev_b32 v14, 16, v171
    v_dot2_f32_bf16 v56, v168, v14, v56
    v_dot2_f32_bf16 v57, v168, v171, v57
    v_dot2_f32_bf16 v58, v169, v14, v58
    v_dot2_f32_bf16 v59, v169, v171, v59
    v_dot2_f32_bf16 v60, v170, v14, v60
    v_dot2_f32_bf16 v61, v170, v171, v61
    v_lshrrev_b32 v14, 16, v175
    v_dot2_f32_bf16 v56, v172, v14, v56
    v_dot2_f32_bf16 v57, v172, v175, v57
    v_dot2_f32_bf16 v58, v173, v14, v58
    v_dot2_f32_bf16 v59, v173, v175, v59
    v_dot2_f32_bf16 v60, v174, v14, v60
    v_dot2_f32_bf16 v61, v174, v175, v61
    s_add_u32 s72, s73, 43008
    buffer_load_dwordx4 v[168:171], v2, s[32:35], s72 offen offset:0 nt
    s_add_u32 s72, s73, 43008
    buffer_load_dwordx4 v[172:175], v2, s[32:35], s72 offen offset:128 nt
    s_waitcnt vmcnt(46)
    v_lshrrev_b32 v14, 16, v179
    v_dot2_f32_bf16 v56, v176, v14, v56
    v_dot2_f32_bf16 v57, v176, v179, v57
    v_dot2_f32_bf16 v58, v177, v14, v58
    v_dot2_f32_bf16 v59, v177, v179, v59
    v_dot2_f32_bf16 v60, v178, v14, v60
    v_dot2_f32_bf16 v61, v178, v179, v61
    v_lshrrev_b32 v14, 16, v183
    v_dot2_f32_bf16 v56, v180, v14, v56
    v_dot2_f32_bf16 v57, v180, v183, v57
    v_dot2_f32_bf16 v58, v181, v14, v58
    v_dot2_f32_bf16 v59, v181, v183, v59
    v_dot2_f32_bf16 v60, v182, v14, v60
    v_dot2_f32_bf16 v61, v182, v183, v61
    s_add_u32 s72, s73, 43008
    buffer_load_dwordx4 v[176:179], v2, s[32:35], s72 offen offset:256 nt
    s_add_u32 s72, s73, 46080
    buffer_load_dwordx4 v[180:183], v2, s[32:35], s72 offen offset:0 nt
    s_waitcnt vmcnt(46)
    v_lshrrev_b32 v14, 16, v187
    v_dot2_f32_bf16 v56, v184, v14, v56
    v_dot2_f32_bf16 v57, v184, v187, v57
    v_dot2_f32_bf16 v58, v185, v14, v58
    v_dot2_f32_bf16 v59, v185, v187, v59
    v_dot2_f32_bf16 v60, v186, v14, v60
    v_dot2_f32_bf16 v61, v186, v187, v61
    v_lshrrev_b32 v14, 16, v191
    v_dot2_f32_bf16 v56, v188, v14, v56
    v_dot2_f32_bf16 v57, v188, v191, v57
    v_dot2_f32_bf16 v58, v189, v14, v58
    v_dot2_f32_bf16 v59, v189, v191, v59
    v_dot2_f32_bf16 v60, v190, v14, v60
    v_dot2_f32_bf16 v61, v190, v191, v61
    s_add_u32 s72, s73, 46080
    buffer_load_dwordx4 v[184:187], v2, s[32:35], s72 offen offset:128 nt
    s_add_u32 s72, s73, 46080
    buffer_load_dwordx4 v[188:191], v2, s[32:35], s72 offen offset:256 nt
    s_waitcnt vmcnt(46)
    v_lshrrev_b32 v14, 16, v195
    v_dot2_f32_bf16 v56, v192, v14, v56
    v_dot2_f32_bf16 v57, v192, v195, v57
    v_dot2_f32_bf16 v58, v193, v14, v58
    v_dot2_f32_bf16 v59, v193, v195, v59
    v_dot2_f32_bf16 v60, v194, v14, v60
    v_dot2_f32_bf16 v61, v194, v195, v61
    v_lshrrev_b32 v14, 16, v199
    v_dot2_f32_bf16 v56, v196, v14, v56
    v_dot2_f32_bf16 v57, v196, v199, v57
    v_dot2_f32_bf16 v58, v197, v14, v58
    v_dot2_f32_bf16 v59, v197, v199, v59
    v_dot2_f32_bf16 v60, v198, v14, v60
    v_dot2_f32_bf16 v61, v198, v199, v61
    s_add_u32 s72, s73, 24576
    buffer_load_dwordx3 v[192:194], v3, s[36:39], s72 offen nt
    s_add_u32 s72, s73, 25344
    buffer_load_dwordx3 v[196:198], v3, s[36:39], s72 offen nt
    s_waitcnt vmcnt(46)
    v_lshrrev_b32 v14, 16, v203
    v_dot2_f32_bf16 v56, v200, v14, v56
    v_dot2_f32_bf16 v57, v200, v203, v57
    v_dot2_f32_bf16 v58, v201, v14, v58
    v_dot2_f32_bf16 v59, v201, v203, v59
    v_dot2_f32_bf16 v60, v202, v14, v60
    v_dot2_f32_bf16 v61, v202, v203, v61
    v_lshrrev_b32 v14, 16, v207
    v_dot2_f32_bf16 v56, v204, v14, v56
    v_dot2_f32_bf16 v57, v204, v207, v57
    v_dot2_f32_bf16 v58, v205, v14, v58
    v_dot2_f32_bf16 v59, v205, v207, v59
    v_dot2_f32_bf16 v60, v206, v14, v60
    v_dot2_f32_bf16 v61, v206, v207, v61
    s_add_u32 s72, s73, 26112
    buffer_load_dwordx3 v[200:202], v3, s[36:39], s72 offen nt
    s_add_u32 s72, s73, 26880
    buffer_load_dwordx3 v[204:206], v3, s[36:39], s72 offen nt
    s_waitcnt vmcnt(46)
    v_lshrrev_b32 v14, 16, v211
    v_dot2_f32_bf16 v56, v208, v14, v56
    v_dot2_f32_bf16 v57, v208, v211, v57
    v_dot2_f32_bf16 v58, v209, v14, v58
    v_dot2_f32_bf16 v59, v209, v211, v59
    v_dot2_f32_bf16 v60, v210, v14, v60
    v_dot2_f32_bf16 v61, v210, v211, v61
    v_lshrrev_b32 v14, 16, v215
    v_dot2_f32_bf16 v56, v212, v14, v56
    v_dot2_f32_bf16 v57, v212, v215, v57
    v_dot2_f32_bf16 v58, v213, v14, v58
    v_dot2_f32_bf16 v59, v213, v215, v59
    v_dot2_f32_bf16 v60, v214, v14, v60
    v_dot2_f32_bf16 v61, v214, v215, v61
    s_add_u32 s72, s73, 27648
    buffer_load_dwordx3 v[208:210], v3, s[36:39], s72 offen nt
    s_add_u32 s72, s73, 28416
    buffer_load_dwordx3 v[212:214], v3, s[36:39], s72 offen nt
    s_waitcnt vmcnt(46)
    v_lshrrev_b32 v14, 16, v219
    v_dot2_f32_bf16 v56, v216, v14, v56
    v_dot2_f32_bf16 v57, v216, v219, v57
    v_dot2_f32_bf16 v58, v217, v14, v58
    v_dot2_f32_bf16 v59, v217, v219, v59
    v_dot2_f32_bf16 v60, v218, v14, v60
    v_dot2_f32_bf16 v61, v218, v219, v61
    v_lshrrev_b32 v14, 16, v223
    v_dot2_f32_bf16 v56, v220, v14, v56
    v_dot2_f32_bf16 v57, v220, v223, v57
    v_dot2_f32_bf16 v58, v221, v14, v58
    v_dot2_f32_bf16 v59, v221, v223, v59
    v_dot2_f32_bf16 v60, v222, v14, v60
    v_dot2_f32_bf16 v61, v222, v223, v61
    s_add_u32 s72, s73, 29184
    buffer_load_dwordx3 v[216:218], v3, s[36:39], s72 offen nt
    s_add_u32 s72, s73, 29952
    buffer_load_dwordx3 v[220:222], v3, s[36:39], s72 offen nt
    s_waitcnt vmcnt(46)
    v_lshrrev_b32 v14, 16, v227
    v_dot2_f32_bf16 v56, v224, v14, v56
    v_dot2_f32_bf16 v57, v224, v227, v57
    v_dot2_f32_bf16 v58, v225, v14, v58
    v_dot2_f32_bf16 v59, v225, v227, v59
    v_dot2_f32_bf16 v60, v226, v14, v60
    v_dot2_f32_bf16 v61, v226, v227, v61
    v_lshrrev_b32 v14, 16, v231
    v_dot2_f32_bf16 v56, v228, v14, v56
    v_dot2_f32_bf16 v57, v228, v231, v57
    v_dot2_f32_bf16 v58, v229, v14, v58
    v_dot2_f32_bf16 v59, v229, v231, v59
    v_dot2_f32_bf16 v60, v230, v14, v60
    v_dot2_f32_bf16 v61, v230, v231, v61
    s_add_u32 s72, s73, 30720
    buffer_load_dwordx3 v[224:226], v3, s[36:39], s72 offen nt
    s_add_u32 s72, s73, 31488
    buffer_load_dwordx3 v[228:230], v3, s[36:39], s72 offen nt
    s_waitcnt vmcnt(46)
    v_lshrrev_b32 v14, 16, v235
    v_dot2_f32_bf16 v56, v232, v14, v56
    v_dot2_f32_bf16 v57, v232, v235, v57
    v_dot2_f32_bf16 v58, v233, v14, v58
    v_dot2_f32_bf16 v59, v233, v235, v59
    v_dot2_f32_bf16 v60, v234, v14, v60
    v_dot2_f32_bf16 v61, v234, v235, v61
    v_lshrrev_b32 v14, 16, v239
    v_dot2_f32_bf16 v56, v236, v14, v56
    v_dot2_f32_bf16 v57, v236, v239, v57
    v_dot2_f32_bf16 v58, v237, v14, v58
    v_dot2_f32_bf16 v59, v237, v239, v59
    v_dot2_f32_bf16 v60, v238, v14, v60
    v_dot2_f32_bf16 v61, v238, v239, v61
    s_add_u32 s72, s73, 32256
    buffer_load_dwordx3 v[232:234], v3, s[36:39], s72 offen nt
    s_add_u32 s72, s73, 33024
    buffer_load_dwordx3 v[236:238], v3, s[36:39], s72 offen nt
    s_waitcnt vmcnt(46)
    v_lshrrev_b32 v14, 16, v243
    v_dot2_f32_bf16 v56, v240, v14, v56
    v_dot2_f32_bf16 v57, v240, v243, v57
    v_dot2_f32_bf16 v58, v241, v14, v58
    v_dot2_f32_bf16 v59, v241, v243, v59
    v_dot2_f32_bf16 v60, v242, v14, v60
    v_dot2_f32_bf16 v61, v242, v243, v61
    v_lshrrev_b32 v14, 16, v247
    v_dot2_f32_bf16 v56, v244, v14, v56
    v_dot2_f32_bf16 v57, v244, v247, v57
    v_dot2_f32_bf16 v58, v245, v14, v58
    v_dot2_f32_bf16 v59, v245, v247, v59
    v_dot2_f32_bf16 v60, v246, v14, v60
    v_dot2_f32_bf16 v61, v246, v247, v61
    s_add_u32 s72, s73, 33792
    buffer_load_dwordx3 v[240:242], v3, s[36:39], s72 offen nt
    s_add_u32 s72, s73, 34560
    buffer_load_dwordx3 v[244:246], v3, s[36:39], s72 offen nt
    s_waitcnt vmcnt(46)
    v_lshrrev_b32 v14, 16, v251
    v_dot2_f32_bf16 v56, v248, v14, v56
    v_dot2_f32_bf16 v57, v248, v251, v57
    v_dot2_f32_bf16 v58, v249, v14, v58
    v_dot2_f32_bf16 v59, v249, v251, v59
    v_dot2_f32_bf16 v60, v250, v14, v60
    v_dot2_f32_bf16 v61, v250, v251, v61
    v_lshrrev_b32 v14, 16, v255
    v_dot2_f32_bf16 v56, v252, v14, v56
    v_dot2_f32_bf16 v57, v252, v255, v57
    v_dot2_f32_bf16 v58, v253, v14, v58
    v_dot2_f32_bf16 v59, v253, v255, v59
    v_dot2_f32_bf16 v60, v254, v14, v60
    v_dot2_f32_bf16 v61, v254, v255, v61
    s_add_u32 s72, s73, 35328
    buffer_load_dwordx3 v[248:250], v3, s[36:39], s72 offen nt
    s_add_u32 s72, s73, 36096
    buffer_load_dwordx3 v[252:254], v3, s[36:39], s72 offen nt
    s_waitcnt vmcnt(46)
    v_lshrrev_b32 v14, 16, v67
    v_dot2_f32_bf16 v56, v64, v14, v56
    v_dot2_f32_bf16 v57, v64, v67, v57
    v_dot2_f32_bf16 v58, v65, v14, v58
    v_dot2_f32_bf16 v59, v65, v67, v59
    v_dot2_f32_bf16 v60, v66, v14, v60
    v_dot2_f32_bf16 v61, v66, v67, v61
    v_lshrrev_b32 v14, 16, v71
    v_dot2_f32_bf16 v56, v68, v14, v56
    v_dot2_f32_bf16 v57, v68, v71, v57
    v_dot2_f32_bf16 v58, v69, v14, v58
    v_dot2_f32_bf16 v59, v69, v71, v59
    v_dot2_f32_bf16 v60, v70, v14, v60
    v_dot2_f32_bf16 v61, v70, v71, v61
    s_add_u32 s72, s73, 36864
    buffer_load_dwordx3 v[64:66], v3, s[36:39], s72 offen nt
    s_add_u32 s72, s73, 37632
    buffer_load_dwordx3 v[68:70], v3, s[36:39], s72 offen nt
    s_waitcnt vmcnt(46)
    v_lshrrev_b32 v14, 16, v75
    v_dot2_f32_bf16 v56, v72, v14, v56
    v_dot2_f32_bf16 v57, v72, v75, v57
    v_dot2_f32_bf16 v58, v73, v14, v58
    v_dot2_f32_bf16 v59, v73, v75, v59
    v_dot2_f32_bf16 v60, v74, v14, v60
    v_dot2_f32_bf16 v61, v74, v75, v61
    v_lshrrev_b32 v14, 16, v79
    v_dot2_f32_bf16 v56, v76, v14, v56
    v_dot2_f32_bf16 v57, v76, v79, v57
    v_dot2_f32_bf16 v58, v77, v14, v58
    v_dot2_f32_bf16 v59, v77, v79, v59
    v_dot2_f32_bf16 v60, v78, v14, v60
    v_dot2_f32_bf16 v61, v78, v79, v61
    s_add_u32 s72, s73, 38400
    buffer_load_dwordx3 v[72:74], v3, s[36:39], s72 offen nt
    s_add_u32 s72, s73, 39168
    buffer_load_dwordx3 v[76:78], v3, s[36:39], s72 offen nt
    s_waitcnt vmcnt(46)
    v_lshrrev_b32 v14, 16, v83
    v_dot2_f32_bf16 v56, v80, v14, v56
    v_dot2_f32_bf16 v57, v80, v83, v57
    v_dot2_f32_bf16 v58, v81, v14, v58
    v_dot2_f32_bf16 v59, v81, v83, v59
    v_dot2_f32_bf16 v60, v82, v14, v60
    v_dot2_f32_bf16 v61, v82, v83, v61
    v_lshrrev_b32 v14, 16, v87
    v_dot2_f32_bf16 v56, v84, v14, v56
    v_dot2_f32_bf16 v57, v84, v87, v57
    v_dot2_f32_bf16 v58, v85, v14, v58
    v_dot2_f32_bf16 v59, v85, v87, v59
    v_dot2_f32_bf16 v60, v86, v14, v60
    v_dot2_f32_bf16 v61, v86, v87, v61
    s_add_u32 s72, s73, 39936
    buffer_load_dwordx3 v[80:82], v3, s[36:39], s72 offen nt
    s_add_u32 s72, s73, 40704
    buffer_load_dwordx3 v[84:86], v3, s[36:39], s72 offen nt
    s_waitcnt vmcnt(46)
    v_lshrrev_b32 v14, 16, v91
    v_dot2_f32_bf16 v56, v88, v14, v56
    v_dot2_f32_bf16 v57, v88, v91, v57
    v_dot2_f32_bf16 v58, v89, v14, v58
    v_dot2_f32_bf16 v59, v89, v91, v59
    v_dot2_f32_bf16 v60, v90, v14, v60
    v_dot2_f32_bf16 v61, v90, v91, v61
    v_lshrrev_b32 v14, 16, v95
    v_dot2_f32_bf16 v56, v92, v14, v56
    v_dot2_f32_bf16 v57, v92, v95, v57
    v_dot2_f32_bf16 v58, v93, v14, v58
    v_dot2_f32_bf16 v59, v93, v95, v59
    v_dot2_f32_bf16 v60, v94, v14, v60
    v_dot2_f32_bf16 v61, v94, v95, v61
    s_add_u32 s72, s73, 41472
    buffer_load_dwordx3 v[88:90], v3, s[36:39], s72 offen nt
    s_add_u32 s72, s73, 42240
    buffer_load_dwordx3 v[92:94], v3, s[36:39], s72 offen nt
    s_waitcnt vmcnt(45)
    v_mfma_f32_16x16x32_bf16 v[40:43], v[16:19], v[96:99], 0
    v_mfma_f32_16x16x32_bf16 v[40:43], v[20:23], v[100:103], v[40:43]
    v_mfma_f32_16x16x32_bf16 v[40:43], v[24:27], v[104:107], v[40:43]
    s_add_u32 s72, s73, 43008
    buffer_load_dwordx3 v[96:98], v3, s[36:39], s72 offen nt
    s_add_u32 s72, s73, 43776
    buffer_load_dwordx3 v[100:102], v3, s[36:39], s72 offen nt
    s_add_u32 s72, s73, 44544
    buffer_load_dwordx3 v[104:106], v3, s[36:39], s72 offen nt
    s_waitcnt vmcnt(45)
    v_mfma_f32_16x16x32_bf16 v[44:47], v[16:19], v[108:111], 0
    v_mfma_f32_16x16x32_bf16 v[44:47], v[20:23], v[112:115], v[44:47]
    v_mfma_f32_16x16x32_bf16 v[44:47], v[24:27], v[116:119], v[44:47]
    s_add_u32 s72, s73, 45312
    buffer_load_dwordx3 v[108:110], v3, s[36:39], s72 offen nt
    s_add_u32 s72, s73, 46080
    buffer_load_dwordx3 v[112:114], v3, s[36:39], s72 offen nt
    s_add_u32 s72, s73, 46848
    buffer_load_dwordx3 v[116:118], v3, s[36:39], s72 offen nt
    s_waitcnt vmcnt(45)
    v_mfma_f32_16x16x32_bf16 v[48:51], v[16:19], v[120:123], 0
    v_mfma_f32_16x16x32_bf16 v[48:51], v[20:23], v[124:127], v[48:51]
    v_mfma_f32_16x16x32_bf16 v[48:51], v[24:27], v[128:131], v[48:51]
    s_add_u32 s72, s73, 47616
    buffer_load_dwordx3 v[120:122], v3, s[36:39], s72 offen nt
    s_add_u32 s72, s73, 48384
    buffer_load_dwordx3 v[124:126], v3, s[36:39], s72 offen nt
    s_waitcnt vmcnt(44)
    v_mfma_f32_16x16x32_bf16 v[52:55], v[16:19], v[132:135], 0
    v_mfma_f32_16x16x32_bf16 v[52:55], v[20:23], v[136:139], v[52:55]
    v_mfma_f32_16x16x32_bf16 v[52:55], v[24:27], v[140:143], v[52:55]
    s_nop 9
    v_cndmask_b32 v40, v40, v41, s[20:21]
    v_cndmask_b32 v44, v44, v45, s[20:21]
    v_cndmask_b32 v48, v48, v49, s[20:21]
    v_cndmask_b32 v52, v52, v53, s[20:21]
    s_nop 0
    v_add_f32_dpp v41, v40, v40 row_ror:8 row_mask:0xf bank_mask:0xf
    v_add_f32_dpp v45, v44, v44 row_ror:8 row_mask:0xf bank_mask:0xf
    v_add_f32_dpp v49, v48, v48 row_ror:8 row_mask:0xf bank_mask:0xf
    v_add_f32_dpp v53, v52, v52 row_ror:8 row_mask:0xf bank_mask:0xf
    v_mov_b32 v62, v41
    v_cndmask_b32 v62, v62, v45, s[6:7]
    v_cndmask_b32 v62, v62, v49, s[8:9]
    v_cndmask_b32 v62, v62, v53, s[10:11]
    s_waitcnt vmcnt(41)
    v_mfma_f32_16x16x32_bf16 v[40:43], v[16:19], v[144:147], 0
    v_mfma_f32_16x16x32_bf16 v[40:43], v[20:23], v[148:151], v[40:43]
    v_mfma_f32_16x16x32_bf16 v[40:43], v[24:27], v[152:155], v[40:43]
    s_waitcnt vmcnt(38)
    v_mfma_f32_16x16x32_bf16 v[44:47], v[16:19], v[156:159], 0
    v_mfma_f32_16x16x32_bf16 v[44:47], v[20:23], v[160:163], v[44:47]
    v_mfma_f32_16x16x32_bf16 v[44:47], v[24:27], v[164:167], v[44:47]
    s_waitcnt vmcnt(35)
    v_mfma_f32_16x16x32_bf16 v[48:51], v[16:19], v[168:171], 0
    v_mfma_f32_16x16x32_bf16 v[48:51], v[20:23], v[172:175], v[48:51]
    v_mfma_f32_16x16x32_bf16 v[48:51], v[24:27], v[176:179], v[48:51]
    s_waitcnt vmcnt(32)
    v_mfma_f32_16x16x32_bf16 v[52:55], v[16:19], v[180:183], 0
    v_mfma_f32_16x16x32_bf16 v[52:55], v[20:23], v[184:187], v[52:55]
    v_mfma_f32_16x16x32_bf16 v[52:55], v[24:27], v[188:191], v[52:55]
    s_nop 9
    v_cndmask_b32 v40, v40, v41, s[20:21]
    v_cndmask_b32 v44, v44, v45, s[20:21]
    v_cndmask_b32 v48, v48, v49, s[20:21]
    v_cndmask_b32 v52, v52, v53, s[20:21]
    s_nop 0
    v_add_f32_dpp v41, v40, v40 row_ror:8 row_mask:0xf bank_mask:0xf
    v_add_f32_dpp v45, v44, v44 row_ror:8 row_mask:0xf bank_mask:0xf
    v_add_f32_dpp v49, v48, v48 row_ror:8 row_mask:0xf bank_mask:0xf
    v_add_f32_dpp v53, v52, v52 row_ror:8 row_mask:0xf bank_mask:0xf
    v_cndmask_b32 v62, v62, v41, s[12:13]
    v_cndmask_b32 v62, v62, v45, s[14:15]
    v_cndmask_b32 v62, v62, v49, s[16:17]
    v_cndmask_b32 v62, v62, v53, s[18:19]
    v_cvt_pk_bf16_f32 v62, v62, v62
    v_and_b32 v62, 0xffff0000, v62
    v_mul_f32 v62, 0x3d93cd3a, v62
    v_cvt_pk_bf16_f32 v62, v62, v62
    v_and_b32 v62, 0xffff0000, v62
    v_mov_b32 v63, v62
    s_nop 1
    v_max_f32_dpp v63, v63, v63 row_shr:1 row_mask:0xf bank_mask:0xf
    s_nop 1
    v_max_f32_dpp v63, v63, v63 row_shr:2 row_mask:0xf bank_mask:0xf
    s_nop 1
    v_max_f32_dpp v63, v63, v63 row_shr:4 row_mask:0xf bank_mask:0xf
    s_nop 1
    v_max_f32_dpp v63, v63, v63 row_shr:8 row_mask:0xf bank_mask:0xf
    s_nop 1
    v_max_f32_dpp v63, v63, v63 row_bcast:15 row_mask:0xa bank_mask:0xf
    s_nop 1
    v_max_f32_dpp v63, v63, v63 row_bcast:31 row_mask:0xc bank_mask:0xf
    s_nop 0
    v_readlane_b32 s76, v63, 63
    s_nop 1
    v_mov_b32 v7, 52429
    v_mul_u32_u24 v7, v0, v7
    v_lshrrev_b32 v7, 22, v7
    v_mul_u32_u24 v8, 80, v7
    v_sub_u32 v8, v0, v8
    v_lshlrev_b32 v9, 2, v7
    s_mul_i32 s72, s68, 192
    s_mul_i32 s74, s69, 24
    s_add_u32 s72, s72, s74
    v_add_u32 v9, s72, v9
    v_mul_u32_u24 v9, 1280, v9
    v_lshlrev_b32 v10, 4, v8
    v_add_u32 v9, v9, v10
    buffer_load_dwordx4 v[144:147], v9, s[44:47], 0 offen offset:0
    buffer_load_dwordx4 v[148:151], v9, s[44:47], 0 offen offset:1280
    buffer_load_dwordx4 v[152:155], v9, s[44:47], 0 offen offset:2560
    buffer_load_dwordx4 v[156:159], v9, s[44:47], 0 offen offset:3840
    s_mul_i32 s72, s30, 6
    v_add_u32 v9, s72, v7
    v_mul_u32_u24 v9, 1280, v9
    v_add_u32 v9, v9, v10
    buffer_load_dwordx4 v[140:143], v9, s[52:55], 0 offen
    v_mov_b32 v138, v7
    v_mov_b32 v139, v8
    v_and_b32 v9, 7, v0
    v_lshlrev_b32 v9, 2, v9
    v_lshrrev_b32 v10, 3, v0
    v_and_b32 v10, 3, v10
    v_add_u32 v9, v9, v10
    v_lshlrev_b32 v9, 3, v9
    v_mov_b32 v135, v9
    global_load_dword v137, v9, s[26:27] sc1
    v_mov_b32 v6, s76
    v_max_f32 v6, s77, v6
    s_nop 0
    v_readfirstlane_b32 s78, v6
    v_sub_f32 v6, s77, v6
    v_mul_f32 v6, 0x3fb8aa3b, v6
    v_exp_f32 v6, v6
    s_mov_b32 s77, s78
    s_nop 1
    v_subrev_f32 v62, s77, v62
    v_mul_f32 v62, 0x3fb8aa3b, v62
    v_exp_f32 v62, v62
    v_mul_f32 v56, v56, v6
    v_mul_f32 v57, v57, v6
    v_mul_f32 v58, v58, v6
    v_mul_f32 v59, v59, v6
    v_mul_f32 v60, v60, v6
    v_mul_f32 v61, v61, v6
    v_fma_f32 v12, v12, v6, v62
    v_cvt_pk_bf16_f32 v62, v62, v62
    v_and_b32 v62, 0xffff0000, v62
    ds_bpermute_b32 v195, v5, v62 offset:0
    ds_bpermute_b32 v199, v5, v62 offset:8
    ds_bpermute_b32 v203, v5, v62 offset:16
    ds_bpermute_b32 v207, v5, v62 offset:24
    ds_bpermute_b32 v211, v5, v62 offset:32
    ds_bpermute_b32 v215, v5, v62 offset:40
    ds_bpermute_b32 v219, v5, v62 offset:48
    ds_bpermute_b32 v223, v5, v62 offset:56
    s_waitcnt lgkmcnt(0)
    ds_bpermute_b32 v227, v5, v62 offset:64
    ds_bpermute_b32 v231, v5, v62 offset:72
    ds_bpermute_b32 v235, v5, v62 offset:80
    ds_bpermute_b32 v239, v5, v62 offset:88
    ds_bpermute_b32 v243, v5, v62 offset:96
    ds_bpermute_b32 v247, v5, v62 offset:104
    ds_bpermute_b32 v251, v5, v62 offset:112
    ds_bpermute_b32 v255, v5, v62 offset:120
    s_waitcnt lgkmcnt(0)
    ds_bpermute_b32 v67, v5, v62 offset:128
    ds_bpermute_b32 v71, v5, v62 offset:136
    ds_bpermute_b32 v75, v5, v62 offset:144
    ds_bpermute_b32 v79, v5, v62 offset:152
    ds_bpermute_b32 v83, v5, v62 offset:160
    ds_bpermute_b32 v87, v5, v62 offset:168
    ds_bpermute_b32 v91, v5, v62 offset:176
    ds_bpermute_b32 v95, v5, v62 offset:184
    s_waitcnt lgkmcnt(0)
    ds_bpermute_b32 v99, v5, v62 offset:192
    ds_bpermute_b32 v103, v5, v62 offset:200
    ds_bpermute_b32 v107, v5, v62 offset:208
    ds_bpermute_b32 v111, v5, v62 offset:216
    ds_bpermute_b32 v115, v5, v62 offset:224
    ds_bpermute_b32 v119, v5, v62 offset:232
    ds_bpermute_b32 v123, v5, v62 offset:240
    ds_bpermute_b32 v127, v5, v62 offset:248
    s_waitcnt lgkmcnt(0)
    s_waitcnt vmcnt(36)
    v_lshrrev_b32 v14, 16, v195
    v_dot2_f32_bf16 v56, v192, v14, v56
    v_dot2_f32_bf16 v57, v192, v195, v57
    v_dot2_f32_bf16 v58, v193, v14, v58
    v_dot2_f32_bf16 v59, v193, v195, v59
    v_dot2_f32_bf16 v60, v194, v14, v60
    v_dot2_f32_bf16 v61, v194, v195, v61
    v_lshrrev_b32 v14, 16, v199
    v_dot2_f32_bf16 v56, v196, v14, v56
    v_dot2_f32_bf16 v57, v196, v199, v57
    v_dot2_f32_bf16 v58, v197, v14, v58
    v_dot2_f32_bf16 v59, v197, v199, v59
    v_dot2_f32_bf16 v60, v198, v14, v60
    v_dot2_f32_bf16 v61, v198, v199, v61
    s_waitcnt vmcnt(34)
    v_lshrrev_b32 v14, 16, v203
    v_dot2_f32_bf16 v56, v200, v14, v56
    v_dot2_f32_bf16 v57, v200, v203, v57
    v_dot2_f32_bf16 v58, v201, v14, v58
    v_dot2_f32_bf16 v59, v201, v203, v59
    v_dot2_f32_bf16 v60, v202, v14, v60
    v_dot2_f32_bf16 v61, v202, v203, v61
    v_lshrrev_b32 v14, 16, v207
    v_dot2_f32_bf16 v56, v204, v14, v56
    v_dot2_f32_bf16 v57, v204, v207, v57
    v_dot2_f32_bf16 v58, v205, v14, v58
    v_dot2_f32_bf16 v59, v205, v207, v59
    v_dot2_f32_bf16 v60, v206, v14, v60
    v_dot2_f32_bf16 v61, v206, v207, v61
    s_waitcnt vmcnt(32)
    v_lshrrev_b32 v14, 16, v211
    v_dot2_f32_bf16 v56, v208, v14, v56
    v_dot2_f32_bf16 v57, v208, v211, v57
    v_dot2_f32_bf16 v58, v209, v14, v58
    v_dot2_f32_bf16 v59, v209, v211, v59
    v_dot2_f32_bf16 v60, v210, v14, v60
    v_dot2_f32_bf16 v61, v210, v211, v61
    v_lshrrev_b32 v14, 16, v215
    v_dot2_f32_bf16 v56, v212, v14, v56
    v_dot2_f32_bf16 v57, v212, v215, v57
    v_dot2_f32_bf16 v58, v213, v14, v58
    v_dot2_f32_bf16 v59, v213, v215, v59
    v_dot2_f32_bf16 v60, v214, v14, v60
    v_dot2_f32_bf16 v61, v214, v215, v61
    s_waitcnt vmcnt(30)
    v_lshrrev_b32 v14, 16, v219
    v_dot2_f32_bf16 v56, v216, v14, v56
    v_dot2_f32_bf16 v57, v216, v219, v57
    v_dot2_f32_bf16 v58, v217, v14, v58
    v_dot2_f32_bf16 v59, v217, v219, v59
    v_dot2_f32_bf16 v60, v218, v14, v60
    v_dot2_f32_bf16 v61, v218, v219, v61
    v_lshrrev_b32 v14, 16, v223
    v_dot2_f32_bf16 v56, v220, v14, v56
    v_dot2_f32_bf16 v57, v220, v223, v57
    v_dot2_f32_bf16 v58, v221, v14, v58
    v_dot2_f32_bf16 v59, v221, v223, v59
    v_dot2_f32_bf16 v60, v222, v14, v60
    v_dot2_f32_bf16 v61, v222, v223, v61
    s_waitcnt vmcnt(28)
    v_lshrrev_b32 v14, 16, v227
    v_dot2_f32_bf16 v56, v224, v14, v56
    v_dot2_f32_bf16 v57, v224, v227, v57
    v_dot2_f32_bf16 v58, v225, v14, v58
    v_dot2_f32_bf16 v59, v225, v227, v59
    v_dot2_f32_bf16 v60, v226, v14, v60
    v_dot2_f32_bf16 v61, v226, v227, v61
    v_lshrrev_b32 v14, 16, v231
    v_dot2_f32_bf16 v56, v228, v14, v56
    v_dot2_f32_bf16 v57, v228, v231, v57
    v_dot2_f32_bf16 v58, v229, v14, v58
    v_dot2_f32_bf16 v59, v229, v231, v59
    v_dot2_f32_bf16 v60, v230, v14, v60
    v_dot2_f32_bf16 v61, v230, v231, v61
    s_waitcnt vmcnt(26)
    v_lshrrev_b32 v14, 16, v235
    v_dot2_f32_bf16 v56, v232, v14, v56
    v_dot2_f32_bf16 v57, v232, v235, v57
    v_dot2_f32_bf16 v58, v233, v14, v58
    v_dot2_f32_bf16 v59, v233, v235, v59
    v_dot2_f32_bf16 v60, v234, v14, v60
    v_dot2_f32_bf16 v61, v234, v235, v61
    v_lshrrev_b32 v14, 16, v239
    v_dot2_f32_bf16 v56, v236, v14, v56
    v_dot2_f32_bf16 v57, v236, v239, v57
    v_dot2_f32_bf16 v58, v237, v14, v58
    v_dot2_f32_bf16 v59, v237, v239, v59
    v_dot2_f32_bf16 v60, v238, v14, v60
    v_dot2_f32_bf16 v61, v238, v239, v61
    s_waitcnt vmcnt(24)
    v_lshrrev_b32 v14, 16, v243
    v_dot2_f32_bf16 v56, v240, v14, v56
    v_dot2_f32_bf16 v57, v240, v243, v57
    v_dot2_f32_bf16 v58, v241, v14, v58
    v_dot2_f32_bf16 v59, v241, v243, v59
    v_dot2_f32_bf16 v60, v242, v14, v60
    v_dot2_f32_bf16 v61, v242, v243, v61
    v_lshrrev_b32 v14, 16, v247
    v_dot2_f32_bf16 v56, v244, v14, v56
    v_dot2_f32_bf16 v57, v244, v247, v57
    v_dot2_f32_bf16 v58, v245, v14, v58
    v_dot2_f32_bf16 v59, v245, v247, v59
    v_dot2_f32_bf16 v60, v246, v14, v60
    v_dot2_f32_bf16 v61, v246, v247, v61
    s_waitcnt vmcnt(22)
    v_lshrrev_b32 v14, 16, v251
    v_dot2_f32_bf16 v56, v248, v14, v56
    v_dot2_f32_bf16 v57, v248, v251, v57
    v_dot2_f32_bf16 v58, v249, v14, v58
    v_dot2_f32_bf16 v59, v249, v251, v59
    v_dot2_f32_bf16 v60, v250, v14, v60
    v_dot2_f32_bf16 v61, v250, v251, v61
    v_lshrrev_b32 v14, 16, v255
    v_dot2_f32_bf16 v56, v252, v14, v56
    v_dot2_f32_bf16 v57, v252, v255, v57
    v_dot2_f32_bf16 v58, v253, v14, v58
    v_dot2_f32_bf16 v59, v253, v255, v59
    v_dot2_f32_bf16 v60, v254, v14, v60
    v_dot2_f32_bf16 v61, v254, v255, v61
    s_waitcnt vmcnt(20)
    v_lshrrev_b32 v14, 16, v67
    v_dot2_f32_bf16 v56, v64, v14, v56
    v_dot2_f32_bf16 v57, v64, v67, v57
    v_dot2_f32_bf16 v58, v65, v14, v58
    v_dot2_f32_bf16 v59, v65, v67, v59
    v_dot2_f32_bf16 v60, v66, v14, v60
    v_dot2_f32_bf16 v61, v66, v67, v61
    v_lshrrev_b32 v14, 16, v71
    v_dot2_f32_bf16 v56, v68, v14, v56
    v_dot2_f32_bf16 v57, v68, v71, v57
    v_dot2_f32_bf16 v58, v69, v14, v58
    v_dot2_f32_bf16 v59, v69, v71, v59
    v_dot2_f32_bf16 v60, v70, v14, v60
    v_dot2_f32_bf16 v61, v70, v71, v61
    s_waitcnt vmcnt(18)
    v_lshrrev_b32 v14, 16, v75
    v_dot2_f32_bf16 v56, v72, v14, v56
    v_dot2_f32_bf16 v57, v72, v75, v57
    v_dot2_f32_bf16 v58, v73, v14, v58
    v_dot2_f32_bf16 v59, v73, v75, v59
    v_dot2_f32_bf16 v60, v74, v14, v60
    v_dot2_f32_bf16 v61, v74, v75, v61
    v_lshrrev_b32 v14, 16, v79
    v_dot2_f32_bf16 v56, v76, v14, v56
    v_dot2_f32_bf16 v57, v76, v79, v57
    v_dot2_f32_bf16 v58, v77, v14, v58
    v_dot2_f32_bf16 v59, v77, v79, v59
    v_dot2_f32_bf16 v60, v78, v14, v60
    v_dot2_f32_bf16 v61, v78, v79, v61
    s_waitcnt vmcnt(16)
    v_lshrrev_b32 v14, 16, v83
    v_dot2_f32_bf16 v56, v80, v14, v56
    v_dot2_f32_bf16 v57, v80, v83, v57
    v_dot2_f32_bf16 v58, v81, v14, v58
    v_dot2_f32_bf16 v59, v81, v83, v59
    v_dot2_f32_bf16 v60, v82, v14, v60
    v_dot2_f32_bf16 v61, v82, v83, v61
    v_lshrrev_b32 v14, 16, v87
    v_dot2_f32_bf16 v56, v84, v14, v56
    v_dot2_f32_bf16 v57, v84, v87, v57
    v_dot2_f32_bf16 v58, v85, v14, v58
    v_dot2_f32_bf16 v59, v85, v87, v59
    v_dot2_f32_bf16 v60, v86, v14, v60
    v_dot2_f32_bf16 v61, v86, v87, v61
    s_waitcnt vmcnt(14)
    v_lshrrev_b32 v14, 16, v91
    v_dot2_f32_bf16 v56, v88, v14, v56
    v_dot2_f32_bf16 v57, v88, v91, v57
    v_dot2_f32_bf16 v58, v89, v14, v58
    v_dot2_f32_bf16 v59, v89, v91, v59
    v_dot2_f32_bf16 v60, v90, v14, v60
    v_dot2_f32_bf16 v61, v90, v91, v61
    v_lshrrev_b32 v14, 16, v95
    v_dot2_f32_bf16 v56, v92, v14, v56
    v_dot2_f32_bf16 v57, v92, v95, v57
    v_dot2_f32_bf16 v58, v93, v14, v58
    v_dot2_f32_bf16 v59, v93, v95, v59
    v_dot2_f32_bf16 v60, v94, v14, v60
    v_dot2_f32_bf16 v61, v94, v95, v61
    s_waitcnt vmcnt(12)
    v_lshrrev_b32 v14, 16, v99
    v_dot2_f32_bf16 v56, v96, v14, v56
    v_dot2_f32_bf16 v57, v96, v99, v57
    v_dot2_f32_bf16 v58, v97, v14, v58
    v_dot2_f32_bf16 v59, v97, v99, v59
    v_dot2_f32_bf16 v60, v98, v14, v60
    v_dot2_f32_bf16 v61, v98, v99, v61
    v_lshrrev_b32 v14, 16, v103
    v_dot2_f32_bf16 v56, v100, v14, v56
    v_dot2_f32_bf16 v57, v100, v103, v57
    v_dot2_f32_bf16 v58, v101, v14, v58
    v_dot2_f32_bf16 v59, v101, v103, v59
    v_dot2_f32_bf16 v60, v102, v14, v60
    v_dot2_f32_bf16 v61, v102, v103, v61
    s_waitcnt vmcnt(10)
    v_lshrrev_b32 v14, 16, v107
    v_dot2_f32_bf16 v56, v104, v14, v56
    v_dot2_f32_bf16 v57, v104, v107, v57
    v_dot2_f32_bf16 v58, v105, v14, v58
    v_dot2_f32_bf16 v59, v105, v107, v59
    v_dot2_f32_bf16 v60, v106, v14, v60
    v_dot2_f32_bf16 v61, v106, v107, v61
    v_lshrrev_b32 v14, 16, v111
    v_dot2_f32_bf16 v56, v108, v14, v56
    v_dot2_f32_bf16 v57, v108, v111, v57
    v_dot2_f32_bf16 v58, v109, v14, v58
    v_dot2_f32_bf16 v59, v109, v111, v59
    v_dot2_f32_bf16 v60, v110, v14, v60
    v_dot2_f32_bf16 v61, v110, v111, v61
    s_waitcnt vmcnt(8)
    v_lshrrev_b32 v14, 16, v115
    v_dot2_f32_bf16 v56, v112, v14, v56
    v_dot2_f32_bf16 v57, v112, v115, v57
    v_dot2_f32_bf16 v58, v113, v14, v58
    v_dot2_f32_bf16 v59, v113, v115, v59
    v_dot2_f32_bf16 v60, v114, v14, v60
    v_dot2_f32_bf16 v61, v114, v115, v61
    v_lshrrev_b32 v14, 16, v119
    v_dot2_f32_bf16 v56, v116, v14, v56
    v_dot2_f32_bf16 v57, v116, v119, v57
    v_dot2_f32_bf16 v58, v117, v14, v58
    v_dot2_f32_bf16 v59, v117, v119, v59
    v_dot2_f32_bf16 v60, v118, v14, v60
    v_dot2_f32_bf16 v61, v118, v119, v61
    s_waitcnt vmcnt(6)
    v_lshrrev_b32 v14, 16, v123
    v_dot2_f32_bf16 v56, v120, v14, v56
    v_dot2_f32_bf16 v57, v120, v123, v57
    v_dot2_f32_bf16 v58, v121, v14, v58
    v_dot2_f32_bf16 v59, v121, v123, v59
    v_dot2_f32_bf16 v60, v122, v14, v60
    v_dot2_f32_bf16 v61, v122, v123, v61
    v_lshrrev_b32 v14, 16, v127
    v_dot2_f32_bf16 v56, v124, v14, v56
    v_dot2_f32_bf16 v57, v124, v127, v57
    v_dot2_f32_bf16 v58, v125, v14, v58
    v_dot2_f32_bf16 v59, v125, v127, v59
    v_dot2_f32_bf16 v60, v126, v14, v60
    v_dot2_f32_bf16 v61, v126, v127, v61
    s_nop 1
    v_add_f32_dpp v12, v12, v12 row_shr:1 row_mask:0xf bank_mask:0xf
    s_nop 1
    v_add_f32_dpp v12, v12, v12 row_shr:2 row_mask:0xf bank_mask:0xf
    s_nop 1
    v_add_f32_dpp v12, v12, v12 row_shr:4 row_mask:0xf bank_mask:0xf
    s_nop 1
    v_add_f32_dpp v12, v12, v12 row_shr:8 row_mask:0xf bank_mask:0xf
    s_nop 1
    v_add_f32_dpp v12, v12, v12 row_bcast:15 row_mask:0xa bank_mask:0xf
    s_nop 1
    v_add_f32_dpp v12, v12, v12 row_bcast:31 row_mask:0xc bank_mask:0xf
    s_nop 0
    v_readlane_b32 s79, v12, 63
    s_nop 1
    ds_write_b64 v13, v[56:57] offset:5120
    ds_write_b64 v13, v[58:59] offset:5128
    ds_write_b64 v13, v[60:61] offset:5136
    v_mov_b32 v6, s77
    v_mov_b32 v7, s79
    s_lshl_b32 s72, s70, 3
    v_mov_b32 v5, s72
    s_mov_b32 exec_lo, 1
    s_mov_b32 exec_hi, 0
    ds_write_b64 v5, v[6:7] offset:18080
    s_mov_b64 exec, -1
    s_waitcnt lgkmcnt(0)
    s_barrier
    s_cmp_ge_u32 s70, 3
    s_cbranch_scc1 L_comb_done
    v_mov_b32 v5, 0
    ds_read_b64 v[40:41], v5 offset:18080
    ds_read_b64 v[42:43], v5 offset:18088
    ds_read_b64 v[44:45], v5 offset:18096
    ds_read_b64 v[46:47], v5 offset:18104
    ds_read_b64 v[48:49], v5 offset:18112
    ds_read_b64 v[50:51], v5 offset:18120
    ds_read_b64 v[52:53], v5 offset:18128
    ds_read_b64 v[54:55], v5 offset:18136
    v_lshlrev_b32 v5, 2, v0
    ds_read_b32 v64, v5 offset:5120
    ds_read_b32 v65, v5 offset:5888
    ds_read_b32 v66, v5 offset:6656
    ds_read_b32 v67, v5 offset:7424
    ds_read_b32 v68, v5 offset:8192
    ds_read_b32 v69, v5 offset:8960
    ds_read_b32 v70, v5 offset:9728
    ds_read_b32 v71, v5 offset:10496
    ds_read_b32 v72, v5 offset:11264
    ds_read_b32 v73, v5 offset:12032
    ds_read_b32 v74, v5 offset:12800
    ds_read_b32 v75, v5 offset:13568
    ds_read_b32 v76, v5 offset:14336
    ds_read_b32 v77, v5 offset:15104
    ds_read_b32 v78, v5 offset:15872
    ds_read_b32 v79, v5 offset:16640
    s_waitcnt lgkmcnt(0)
    v_max_f32 v6, v40, v42
    v_max_f32 v6, v6, v44
    v_max_f32 v6, v6, v46
    v_max_f32 v6, v6, v48
    v_max_f32 v6, v6, v50
    v_max_f32 v6, v6, v52
    v_max_f32 v6, v6, v54
    v_sub_f32 v40, v40, v6
    v_mul_f32 v40, 0x3fb8aa3b, v40
    v_exp_f32 v40, v40
    v_sub_f32 v42, v42, v6
    v_mul_f32 v42, 0x3fb8aa3b, v42
    v_exp_f32 v42, v42
    v_sub_f32 v44, v44, v6
    v_mul_f32 v44, 0x3fb8aa3b, v44
    v_exp_f32 v44, v44
    v_sub_f32 v46, v46, v6
    v_mul_f32 v46, 0x3fb8aa3b, v46
    v_exp_f32 v46, v46
    v_sub_f32 v48, v48, v6
    v_mul_f32 v48, 0x3fb8aa3b, v48
    v_exp_f32 v48, v48
    v_sub_f32 v50, v50, v6
    v_mul_f32 v50, 0x3fb8aa3b, v50
    v_exp_f32 v50, v50
    v_sub_f32 v52, v52, v6
    v_mul_f32 v52, 0x3fb8aa3b, v52
    v_exp_f32 v52, v52
    v_sub_f32 v54, v54, v6
    v_mul_f32 v54, 0x3fb8aa3b, v54
    v_exp_f32 v54, v54
    s_nop 0
    v_mul_f32 v7, v40, v41
    v_fma_f32 v7, v42, v43, v7
    v_fma_f32 v7, v44, v45, v7
    v_fma_f32 v7, v46, v47, v7
    v_fma_f32 v7, v48, v49, v7
    v_fma_f32 v7, v50, v51, v7
    v_fma_f32 v7, v52, v53, v7
    v_fma_f32 v7, v54, v55, v7
    v_add_f32 v64, v64, v65
    v_add_f32 v66, v66, v67
    v_add_f32 v68, v68, v69
    v_add_f32 v70, v70, v71
    v_add_f32 v72, v72, v73
    v_add_f32 v74, v74, v75
    v_add_f32 v76, v76, v77
    v_add_f32 v78, v78, v79
    v_mul_f32 v8, v40, v64
    v_fma_f32 v8, v42, v66, v8
    v_fma_f32 v8, v44, v68, v8
    v_fma_f32 v8, v46, v70, v8
    v_fma_f32 v8, v48, v72, v8
    v_fma_f32 v8, v50, v74, v8
    v_fma_f32 v8, v52, v76, v8
    v_fma_f32 v8, v54, v78, v8
    ds_write_b32 v5, v8 offset:18432
    s_cmp_lg_u32 s70, 0
    s_cbranch_scc1 L_comb_done
    s_mov_b32 exec_lo, 1
    s_mov_b32 exec_hi, 0
    ds_write_b64 v5, v[6:7] offset:19200
    s_mov_b64 exec, -1
L_comb_done:
    s_waitcnt lgkmcnt(0)
    s_barrier
    s_lshl_b32 s72, s68, 3
    s_add_u32 s72, s72, s69
    s_lshl_b32 s72, s72, 11
    s_add_u32 s72, s72, 262144
    s_cmp_gt_u32 s70, 1
    s_cbranch_scc1 L_opub_done
    v_mul_u32_u24 v5, 12, v0
    ds_read_b32 v40, v5 offset:18432
    ds_read_b32 v41, v5 offset:18436
    ds_read_b32 v42, v5 offset:18440
    v_mov_b32 v43, s86
    v_lshlrev_b32 v6, 4, v0
    v_add_u32 v6, s72, v6
    s_cmp_eq_u32 s70, 0
    s_cbranch_scc1 L_opub_st
    s_mov_b32 exec_lo, 1
    s_mov_b32 exec_hi, 0
L_opub_st:
    s_waitcnt lgkmcnt(0)
    global_store_dwordx4 v6, v[40:43], s[28:29] sc1
    s_mov_b64 exec, -1
L_opub_done:
    s_cmp_gt_u32 s70, 1
    s_cbranch_scc1 L_og_done
    s_lshl_b32 s72, s68, 14
    s_add_u32 s72, s72, 262144
    s_cmp_eq_u32 s70, 1
    s_cbranch_scc1 L_og_ml
    v_lshrrev_b32 v6, 3, v1
    v_lshlrev_b32 v9, 11, v6
    v_and_b32 v7, 7, v1
    s_lshl_b32 s74, s69, 3
    v_add_u32 v8, s74, v7
    v_lshlrev_b32 v8, 4, v8
    v_add_u32 v9, v9, v8
    v_add_u32 v9, s72, v9
    s_mov_b32 s74, 0
L_poll0:
    global_load_dwordx4 v[40:43], v9, s[28:29] offset:0 sc1
    s_waitcnt vmcnt(0)
    v_cmp_ne_u32 vcc, s86, v43
    s_add_u32 s74, s74, 1
    s_nop 3
    s_cbranch_vccz L_poll0_done
    s_cmp_ge_u32 s74, 0x40000
    s_cbranch_scc1 L_poll0_done
    s_sleep 1
    s_branch L_poll0
L_poll0_done:
    v_mul_u32_u24 v5, 96, v6
    v_mul_u32_u24 v7, 12, v7
    v_add_u32 v5, v5, v7
    ds_write_b32 v5, v40 offset:19456
    ds_write_b32 v5, v41 offset:19460
    ds_write_b32 v5, v42 offset:19464
    s_branch L_og_done
L_og_ml:
    s_mov_b32 exec_lo, 0xff
    s_mov_b32 exec_hi, 0
    v_lshlrev_b32 v9, 11, v1
    v_add_u32 v9, s72, v9
    s_mov_b32 s74, 0
L_poll1:
    global_load_dwordx4 v[40:43], v9, s[28:29] offset:1024 sc1
    s_waitcnt vmcnt(0)
    v_cmp_ne_u32 vcc, s86, v43
    s_add_u32 s74, s74, 1
    s_nop 3
    s_cbranch_vccz L_poll1_done
    s_cmp_ge_u32 s74, 0x40000
    s_cbranch_scc1 L_poll1_done
    s_sleep 1
    s_branch L_poll1
L_poll1_done:
    v_lshlrev_b32 v5, 3, v1
    ds_write_b64 v5, v[40:41] offset:20224
    s_mov_b64 exec, -1
L_og_done:
    s_waitcnt lgkmcnt(0)
    s_barrier
    s_cmp_lg_u32 s70, 0
    s_cbranch_scc1 L_ofin_done
    s_mov_b32 exec_lo, 0xffffff
    s_mov_b32 exec_hi, 0
    v_mov_b32 v5, 0
    ds_read_b64 v[40:41], v5 offset:20224
    ds_read_b64 v[42:43], v5 offset:20232
    ds_read_b64 v[44:45], v5 offset:20240
    ds_read_b64 v[46:47], v5 offset:20248
    ds_read_b64 v[48:49], v5 offset:20256
    ds_read_b64 v[50:51], v5 offset:20264
    ds_read_b64 v[52:53], v5 offset:20272
    ds_read_b64 v[54:55], v5 offset:20280
    v_lshlrev_b32 v5, 2, v1
    ds_read_b32 v64, v5 offset:19456
    ds_read_b32 v65, v5 offset:19552
    ds_read_b32 v66, v5 offset:19648
    ds_read_b32 v67, v5 offset:19744
    ds_read_b32 v68, v5 offset:19840
    ds_read_b32 v69, v5 offset:19936
    ds_read_b32 v70, v5 offset:20032
    ds_read_b32 v71, v5 offset:20128
    s_waitcnt lgkmcnt(0)
    v_max_f32 v6, v40, v42
    v_max_f32 v6, v6, v44
    v_max_f32 v6, v6, v46
    v_max_f32 v6, v6, v48
    v_max_f32 v6, v6, v50
    v_max_f32 v6, v6, v52
    v_max_f32 v6, v6, v54
    v_sub_f32 v40, v40, v6
    v_mul_f32 v40, 0x3fb8aa3b, v40
    v_exp_f32 v40, v40
    v_sub_f32 v42, v42, v6
    v_mul_f32 v42, 0x3fb8aa3b, v42
    v_exp_f32 v42, v42
    v_sub_f32 v44, v44, v6
    v_mul_f32 v44, 0x3fb8aa3b, v44
    v_exp_f32 v44, v44
    v_sub_f32 v46, v46, v6
    v_mul_f32 v46, 0x3fb8aa3b, v46
    v_exp_f32 v46, v46
    v_sub_f32 v48, v48, v6
    v_mul_f32 v48, 0x3fb8aa3b, v48
    v_exp_f32 v48, v48
    v_sub_f32 v50, v50, v6
    v_mul_f32 v50, 0x3fb8aa3b, v50
    v_exp_f32 v50, v50
    v_sub_f32 v52, v52, v6
    v_mul_f32 v52, 0x3fb8aa3b, v52
    v_exp_f32 v52, v52
    v_sub_f32 v54, v54, v6
    v_mul_f32 v54, 0x3fb8aa3b, v54
    v_exp_f32 v54, v54
    s_nop 0
    v_mul_f32 v7, v40, v41
    v_fma_f32 v7, v42, v43, v7
    v_fma_f32 v7, v44, v45, v7
    v_fma_f32 v7, v46, v47, v7
    v_fma_f32 v7, v48, v49, v7
    v_fma_f32 v7, v50, v51, v7
    v_fma_f32 v7, v52, v53, v7
    v_fma_f32 v7, v54, v55, v7
    v_mul_f32 v8, v40, v64
    v_fma_f32 v8, v42, v65, v8
    v_fma_f32 v8, v44, v66, v8
    v_fma_f32 v8, v46, v67, v8
    v_fma_f32 v8, v48, v68, v8
    v_fma_f32 v8, v50, v69, v8
    v_fma_f32 v8, v52, v70, v8
    v_fma_f32 v8, v54, v71, v8
    v_rcp_f32 v7, v7
    s_nop 0
    v_mul_f32 v8, v8, v7
    v_cvt_pk_bf16_f32 v8, v8, v8
    v_and_b32 v8, 0xffff0000, v8
    ds_write_b32 v5, v8 offset:18144
    s_mov_b64 exec, -1
    s_waitcnt lgkmcnt(0)
L_ofin_done:
    s_barrier
    v_lshlrev_b32 v5, 4, v138
    ds_read_b128 v[6:9], v5 offset:18144
    v_lshlrev_b32 v5, 2, v138
    ds_read_b32 v10, v5 offset:18048
    v_mov_b32 v40, 0
    v_mov_b32 v41, 0
    v_mov_b32 v42, 0
    v_mov_b32 v43, 0
    v_mov_b32 v44, 0
    v_mov_b32 v45, 0
    v_mov_b32 v46, 0
    v_mov_b32 v47, 0
    v_mov_b32 v48, 0
    v_mov_b32 v49, 0
    v_mov_b32 v50, 0
    v_mov_b32 v51, 0
    v_mov_b32 v52, 0
    v_mov_b32 v53, 0
    v_mov_b32 v54, 0
    v_mov_b32 v55, 0
    s_waitcnt vmcnt(0) lgkmcnt(0)
    v_lshrrev_b32 v14, 16, v6
    v_dot2_f32_bf16 v40, v144, v14, v40
    v_dot2_f32_bf16 v41, v144, v6, v41
    v_dot2_f32_bf16 v42, v145, v14, v42
    v_dot2_f32_bf16 v43, v145, v6, v43
    v_dot2_f32_bf16 v44, v146, v14, v44
    v_dot2_f32_bf16 v45, v146, v6, v45
    v_dot2_f32_bf16 v46, v147, v14, v46
    v_dot2_f32_bf16 v47, v147, v6, v47
    v_lshrrev_b32 v14, 16, v7
    v_dot2_f32_bf16 v40, v148, v14, v40
    v_dot2_f32_bf16 v41, v148, v7, v41
    v_dot2_f32_bf16 v42, v149, v14, v42
    v_dot2_f32_bf16 v43, v149, v7, v43
    v_dot2_f32_bf16 v44, v150, v14, v44
    v_dot2_f32_bf16 v45, v150, v7, v45
    v_dot2_f32_bf16 v46, v151, v14, v46
    v_dot2_f32_bf16 v47, v151, v7, v47
    v_lshrrev_b32 v14, 16, v8
    v_dot2_f32_bf16 v40, v152, v14, v40
    v_dot2_f32_bf16 v41, v152, v8, v41
    v_dot2_f32_bf16 v42, v153, v14, v42
    v_dot2_f32_bf16 v43, v153, v8, v43
    v_dot2_f32_bf16 v44, v154, v14, v44
    v_dot2_f32_bf16 v45, v154, v8, v45
    v_dot2_f32_bf16 v46, v155, v14, v46
    v_dot2_f32_bf16 v47, v155, v8, v47
    v_lshrrev_b32 v14, 16, v9
    v_dot2_f32_bf16 v40, v156, v14, v40
    v_dot2_f32_bf16 v41, v156, v9, v41
    v_dot2_f32_bf16 v42, v157, v14, v42
    v_dot2_f32_bf16 v43, v157, v9, v43
    v_dot2_f32_bf16 v44, v158, v14, v44
    v_dot2_f32_bf16 v45, v158, v9, v45
    v_dot2_f32_bf16 v46, v159, v14, v46
    v_dot2_f32_bf16 v47, v159, v9, v47
    v_lshrrev_b32 v14, 16, v10
    v_dot2_f32_bf16 v48, v140, v14, v48
    v_dot2_f32_bf16 v49, v140, v10, v49
    v_dot2_f32_bf16 v50, v141, v14, v50
    v_dot2_f32_bf16 v51, v141, v10, v51
    v_dot2_f32_bf16 v52, v142, v14, v52
    v_dot2_f32_bf16 v53, v142, v10, v53
    v_dot2_f32_bf16 v54, v143, v14, v54
    v_dot2_f32_bf16 v55, v143, v10, v55
    v_mul_u32_u24 v5, 2560, v138
    v_lshlrev_b32 v6, 5, v139
    v_add_u32 v5, v5, v6
    v_cmp_gt_u32 vcc, 480, v0
    s_and_saveexec_b64 s[78:79], vcc
    s_nop 1
    ds_write_b128 v5, v[40:43] offset:20480
    ds_write_b128 v5, v[44:47] offset:20496
    ds_write_b128 v5, v[48:51] offset:35840
    ds_write_b128 v5, v[52:55] offset:35856
    s_mov_b64 exec, -1
    s_waitcnt lgkmcnt(0)
    s_barrier
    v_cmp_le_u32 vcc, 214, v0
    v_subrev_u32 v6, 214, v0
    s_nop 0
    v_cndmask_b32 v6, v0, v6, vcc
    v_cndmask_b32 v7, 0, 1, vcc
    v_mul_u32_u24 v5, 15360, v7
    v_mul_u32_u24 v8, 12, v6
    v_add_u32 v5, v5, v8
    v_cmp_gt_u32 vcc, 428, v0
    s_and_saveexec_b64 s[78:79], vcc
    s_cbranch_execz L_s2_done
    ds_read_b32 v40, v5 offset:20480
    ds_read_b32 v41, v5 offset:20484
    ds_read_b32 v42, v5 offset:20488
    ds_read_b32 v44, v5 offset:23040
    ds_read_b32 v45, v5 offset:23044
    ds_read_b32 v46, v5 offset:23048
    ds_read_b32 v48, v5 offset:25600
    ds_read_b32 v49, v5 offset:25604
    ds_read_b32 v50, v5 offset:25608
    ds_read_b32 v52, v5 offset:28160
    ds_read_b32 v53, v5 offset:28164
    ds_read_b32 v54, v5 offset:28168
    ds_read_b32 v56, v5 offset:30720
    ds_read_b32 v57, v5 offset:30724
    ds_read_b32 v58, v5 offset:30728
    ds_read_b32 v60, v5 offset:33280
    ds_read_b32 v61, v5 offset:33284
    ds_read_b32 v62, v5 offset:33288
    s_waitcnt lgkmcnt(0)
    v_add_f32 v40, v40, v44
    v_add_f32 v41, v41, v45
    v_add_f32 v42, v42, v46
    v_add_f32 v40, v40, v48
    v_add_f32 v41, v41, v49
    v_add_f32 v42, v42, v50
    v_add_f32 v40, v40, v52
    v_add_f32 v41, v41, v53
    v_add_f32 v42, v42, v54
    v_add_f32 v40, v40, v56
    v_add_f32 v41, v41, v57
    v_add_f32 v42, v42, v58
    v_add_f32 v40, v40, v60
    v_add_f32 v41, v41, v61
    v_add_f32 v42, v42, v62
    v_mov_b32 v43, s86
    v_mul_u32_u24 v9, 3424, v7
    v_lshlrev_b32 v8, 4, v6
    v_add_u32 v9, v9, v8
    s_lshl_b32 s72, s2, 13
    s_add_u32 s72, s72, 1048576
    v_add_u32 v9, s72, v9
    global_store_dwordx4 v9, v[40:43], s[28:29] sc1
L_s2_done:
    s_mov_b64 exec, -1
    s_cmp_ge_u32 s2, 214
    s_cbranch_scc1 L_fin
    v_lshrrev_b32 v7, 8, v0
    v_and_b32 v6, 255, v0
    v_lshlrev_b32 v6, 13, v6
    v_mul_u32_u24 v9, 3424, v7
    v_add_u32 v9, v9, v6
    s_lshl_b32 s72, s2, 4
    s_add_u32 s72, s72, 1048576
    v_add_u32 v9, s72, v9
    s_mul_i32 s72, s2, 3
    v_add_u32 v5, s72, v1
    v_lshlrev_b32 v5, 1, v5
    buffer_load_ushort v44, v5, s[56:59], 0 offen
    buffer_load_ushort v45, v5, s[64:67], 0 offen
    s_mov_b32 s74, 0
L_fpoll:
    global_load_dwordx4 v[40:43], v9, s[28:29] sc1
    s_waitcnt vmcnt(0)
    v_cmp_ne_u32 vcc, v137, v43
    v_cmp_eq_u32 s[78:79], 0, v137
    s_add_u32 s74, s74, 1
    s_nop 3
    s_or_b64 vcc, vcc, s[78:79]
    s_nop 3
    s_cbranch_vccz L_fpoll_done
    s_cmp_ge_u32 s74, 0x40000
    s_cbranch_scc1 L_fpoll_done
    s_mov_b64 exec, vcc
    s_sleep 1
    global_load_dword v137, v135, s[26:27] sc1
    s_branch L_fpoll
L_fpoll_done:
    s_mov_b64 exec, -1
    v_add_f32_dpp v40, v40, v40 row_shr:1 row_mask:0xf bank_mask:0xf
    v_add_f32_dpp v41, v41, v41 row_shr:1 row_mask:0xf bank_mask:0xf
    v_add_f32_dpp v42, v42, v42 row_shr:1 row_mask:0xf bank_mask:0xf
    v_add_f32_dpp v40, v40, v40 row_shr:2 row_mask:0xf bank_mask:0xf
    v_add_f32_dpp v41, v41, v41 row_shr:2 row_mask:0xf bank_mask:0xf
    v_add_f32_dpp v42, v42, v42 row_shr:2 row_mask:0xf bank_mask:0xf
    v_add_f32_dpp v40, v40, v40 row_shr:4 row_mask:0xf bank_mask:0xf
    v_add_f32_dpp v41, v41, v41 row_shr:4 row_mask:0xf bank_mask:0xf
    v_add_f32_dpp v42, v42, v42 row_shr:4 row_mask:0xf bank_mask:0xf
    v_add_f32_dpp v40, v40, v40 row_shr:8 row_mask:0xf bank_mask:0xf
    v_add_f32_dpp v41, v41, v41 row_shr:8 row_mask:0xf bank_mask:0xf
    v_add_f32_dpp v42, v42, v42 row_shr:8 row_mask:0xf bank_mask:0xf
    v_add_f32_dpp v40, v40, v40 row_bcast:15 row_mask:0xa bank_mask:0xf
    v_add_f32_dpp v41, v41, v41 row_bcast:15 row_mask:0xa bank_mask:0xf
    v_add_f32_dpp v42, v42, v42 row_bcast:15 row_mask:0xa bank_mask:0xf
    v_add_f32_dpp v40, v40, v40 row_bcast:31 row_mask:0xc bank_mask:0xf
    v_add_f32_dpp v41, v41, v41 row_bcast:31 row_mask:0xc bank_mask:0xf
    v_add_f32_dpp v42, v42, v42 row_bcast:31 row_mask:0xc bank_mask:0xf
    s_lshl_b32 s72, s70, 4
    v_mov_b32 v6, s72
    s_mov_b32 exec_lo, 0
    s_mov_b32 exec_hi, 0x80000000
    ds_write_b128 v6, v[40:43] offset:18240
    s_mov_b64 exec, -1
    s_waitcnt lgkmcnt(0)
    s_barrier
    s_cmp_lg_u32 s70, 0
    s_cbranch_scc1 L_fin
    s_mov_b32 exec_lo, 0x7
    s_mov_b32 exec_hi, 0
    v_lshlrev_b32 v6, 2, v1
    ds_read_b32 v48, v6 offset:18240
    ds_read_b32 v49, v6 offset:18256
    ds_read_b32 v50, v6 offset:18272
    ds_read_b32 v51, v6 offset:18288
    ds_read_b32 v52, v6 offset:18304
    ds_read_b32 v53, v6 offset:18320
    ds_read_b32 v54, v6 offset:18336
    ds_read_b32 v55, v6 offset:18352
    s_waitcnt lgkmcnt(0)
    v_add_f32 v48, v48, v49
    v_add_f32 v50, v50, v51
    v_add_f32 v48, v48, v50
    v_add_f32 v52, v52, v53
    v_add_f32 v54, v54, v55
    v_add_f32 v52, v52, v54
    v_cvt_pk_bf16_f32 v48, v48, v48
    v_and_b32 v48, 0xffff0000, v48
    v_cvt_pk_bf16_f32 v52, v52, v52
    v_and_b32 v52, 0xffff0000, v52
    v_lshlrev_b32 v45, 16, v45
    v_add_f32 v52, v52, v45
    v_cvt_pk_bf16_f32 v52, v52, v52
    v_and_b32 v52, 0xffff0000, v52
    v_mul_f32 v53, 0xbfb8aa3b, v52
    v_exp_f32 v53, v53
    s_nop 0
    v_add_f32 v53, 1.0, v53
    v_rcp_f32 v53, v53
    s_nop 0
    v_mul_f32 v52, v52, v53
    v_cvt_pk_bf16_f32 v52, v52, v52
    v_and_b32 v52, 0xffff0000, v52
    v_mul_f32 v48, v48, v52
    v_cvt_pk_bf16_f32 v48, v48, v48
    v_and_b32 v48, 0xffff0000, v48
    v_lshlrev_b32 v44, 16, v44
    v_add_f32 v48, v44, v48
    v_cvt_pk_bf16_f32 v48, v48, v48
    v_cmp_gt_u32 vcc, 1280, v5
    s_and_saveexec_b64 s[78:79], vcc
    s_cbranch_execz L_nostore
    global_store_short v5, v48, s[24:25]
L_nostore:
    s_mov_b64 exec, -1
L_fin:
L_end:
    s_endpgm
.section .rodata,"a"
.p2align 6
.amdhsa_kernel recurrent_scan__gqa_block_cached__mixer_channel_mlp__decode_kernel
  .amdhsa_next_free_vgpr 256
  .amdhsa_next_free_sgpr 102
  .amdhsa_accum_offset 256
  .amdhsa_group_segment_fixed_size 0
  .amdhsa_kernarg_size 104
  .amdhsa_user_sgpr_count 2
  .amdhsa_user_sgpr_kernarg_segment_ptr 1
  .amdhsa_system_sgpr_workgroup_id_x 1
.end_amdhsa_kernel
```
